```python
import torch

def _softmax(x, axis=-1):
    return torch.softmax(x, dim=axis)
def _gelu(x):
    return torch.nn.functional.gelu(x, approximate="tanh")
def _silu(x):
    return torch.nn.functional.silu(x)
def _sigmoid(x):
    return torch.sigmoid(x)
def _layernorm(x, axis=-1, eps=1e-5):
    m = x.mean(dim=axis, keepdim=True)
    v = x.var(dim=axis, keepdim=True, unbiased=False)
    return (x - m) / torch.sqrt(v + eps)
def _scatter_add(tgt, idx, src, axis=0):
    return tgt.clone().index_add_(axis, idx, src)
def _segment_sum(src, seg, n):
    out = torch.zeros((n,) + src.shape[1:], dtype=src.dtype)
    return out.index_add_(0, seg, src)
def _pad(x, pw):
    flat = tuple(v for pair in reversed(pw) for v in pair)
    return torch.nn.functional.pad(x, flat)

kernel_name = 'gated_mix__spectral_gfnet__swiglu_ffn__prompt'

def setup_inputs():

    _w = (lambda a: (lambda t: t.to(torch.bfloat16) if t.is_floating_point() else t)(torch.as_tensor(a)))
    def _A_setup():
        B, S, D = 1, 2048, 512
        Df = D // 2 + 1
        return {
            "x": _w((lambda *s: torch.randn(*s, dtype=torch.bfloat16) * 0.05)(B, S, D)),
            "w_r": _w((lambda *s: torch.randn(*s, dtype=torch.bfloat16) * 0.8)(S, Df) * 0.02),
            "w_i": _w((lambda *s: torch.randn(*s, dtype=torch.bfloat16) * 0.8)(S, Df) * 0.02),
        }
    _A_in = _A_setup()

    def _B_setup():
        B, S, D, F = 1, 2048, 512, 1376
        return {
            "x": _w((lambda *s: torch.randn(*s, dtype=torch.bfloat16) * 0.05)(B, S, D)),
            "w_gate": _w((lambda *s: torch.randn(*s, dtype=torch.bfloat16) * 0.05)(D, F)),
            "w_up": _w((lambda *s: torch.randn(*s, dtype=torch.bfloat16) * 0.05)(D, F)),
            "w_down": _w((lambda *s: torch.randn(*s, dtype=torch.bfloat16) * 0.05)(F, D)),
        }
    _B_in = _B_setup()

    return {
        "A_x": _A_in["x"],
        "A_w_r": _A_in["w_r"],
        "A_w_i": _A_in["w_i"],
        "B_x": _B_in["x"],
        "B_w_gate": _B_in["w_gate"],
        "B_w_up": _B_in["w_up"],
        "B_w_down": _B_in["w_down"],
        "gate_w": _w((lambda *s: torch.randn(*s, dtype=torch.bfloat16) * 0.05)(512) * 16.0),
    }

def reference(A_x, A_w_r, A_w_i, B_x, B_w_gate, B_w_up, B_w_down, gate_w):
    def _A_ref(x, w_r, w_i):
        B, S, D = x.shape
        X = (lambda x, axes=(-2,-1): torch.fft.rfft2(x.float(), dim=axes))(x, axes=(-2, -1))
        W = w_r + 1j * w_i
        X = X * W
        y = (lambda x, s, axes=(-2,-1): torch.fft.irfft2(x, s=s, dim=axes).to(torch.bfloat16))(X, (S, D), axes=(-2, -1))
        return y

    def _B_ref(x, w_gate, w_up, w_down):
        g = _silu(x @ w_gate)
        u = x @ w_up
        return (g * u) @ w_down

    x = A_x
    g = _sigmoid((x * gate_w).sum(-1, keepdims=True))
    a = _A_ref(x, A_w_r, A_w_i)
    b = _B_ref(x, B_w_gate, B_w_up, B_w_down)
    return g * a + (1 - g) * b
```

```asm
; @launch kernel=k1_kernel grid=(256,1,1) block=(256,1,1) lds=157952
; @launch kernel=k2_kernel grid=(257,1,1) block=(256,1,1) lds=55296
; @launch kernel=k3_kernel grid=(256,1,1) block=(256,1,1) lds=35072
.amdgcn_target "amdgcn-amd-amdhsa--gfx950"
.text
.globl k1_kernel
.p2align 8
.type k1_kernel,@function
k1_kernel:
    s_cmp_ge_u32 s2, 256
    s_cbranch_scc1 K1_EXIT
    s_load_dwordx2 s[4:5], s[0:1], 0
    s_load_dwordx4 s[8:11], s[0:1], 8
    s_load_dwordx2 s[6:7], s[0:1], 56
    s_load_dwordx2 s[12:13], s[0:1], 80
    s_load_dwordx4 s[52:55], s[0:1], 32
    s_load_dwordx2 s[50:51], s[0:1], 48
    s_mov_b32 s30, 0x3f3504f3
    v_lshrrev_b32 v1, 6, v0
    s_nop 0
    v_readfirstlane_b32 s3, v1
    s_bfe_u32 s56, s2, 0x10002
    s_lshl_b32 s56, s56, 3
    s_bfe_u32 s96, s2, 0x30003
    s_add_u32 s56, s56, s96
    s_and_b32 s96, s2, 3
    s_lshl_b32 s96, s96, 2
    s_lshr_b32 s57, s2, 6
    s_add_u32 s57, s57, s96
    s_waitcnt lgkmcnt(0)
    s_mov_b32 s16, s4
    s_mov_b32 s17, s5
    s_mov_b32 s18, 0x200000
    s_mov_b32 s19, 0x00020000
    s_mov_b32 s20, s6
    s_mov_b32 s21, s7
    s_mov_b32 s22, 0x400
    s_mov_b32 s23, 0x00020000
    s_mov_b32 s24, s12
    s_mov_b32 s25, s13
    s_mov_b32 s26, 0x414100
    s_mov_b32 s27, 0x00020000
    s_add_u32 s32, s12, 0xf00000
    s_addc_u32 s33, s13, 0
    s_mov_b32 s34, 0x2000
    s_mov_b32 s35, 0x00020000
    s_mov_b32 s36, s8
    s_mov_b32 s37, s9
    s_mov_b32 s38, 0x101002
    s_mov_b32 s39, 0x00020000
    s_mov_b32 s40, s10
    s_mov_b32 s41, s11
    s_mov_b32 s42, 0x101002
    s_mov_b32 s43, 0x00020000
    s_add_u32 s44, s12, 0x480000
    s_addc_u32 s45, s13, 0
    s_mov_b32 s46, 0x212100
    s_mov_b32 s47, 0x00020000
    s_cmp_ge_u32 s3, 2
    s_cselect_b32 s64, s54, s52
    s_cselect_b32 s65, s55, s53
    s_mov_b32 s66, 0x158000
    s_mov_b32 s67, 0x00020000
    s_mov_b32 s4, s2
    s_and_b32 s96, s2, 7
    s_lshl_b32 s96, s96, 5
    s_lshr_b32 s2, s2, 3
    s_add_u32 s2, s2, s96
    s_cmp_ge_u32 s57, 15
    s_cbranch_scc1 K1_PACK
    v_and_b32 v1, 63, v0
    v_lshrrev_b32 v2, 6, v0
    s_lshl_b32 s14, s2, 3
    s_lshl_b32 s15, s3, 1
    s_add_u32 s14, s14, s15
    s_lshl_b32 s15, s14, 10
    s_add_u32 s28, s15, 1024
    v_lshlrev_b32 v3, 4, v1
    s_mul_i32 s31, s3, 4608
    s_add_u32 m0, s31, 122880
    s_nop 0
    buffer_load_dwordx4 v3, s[16:19], s15 offen lds
    s_add_u32 m0, s31, 123904
    s_nop 0
    buffer_load_dwordx4 v3, s[16:19], s28 offen lds
    s_add_u32 m0, s31, 124928
    s_nop 0
    buffer_load_dwordx4 v3, s[20:23], 0 offen lds
    s_add_u32 s68, s12, 0x700000
    s_addc_u32 s69, s13, 0
    s_mov_b32 s70, 0x560000
    s_mov_b32 s71, 0x00020000
    s_and_b32 s58, s3, 1
    s_lshr_b32 s59, s3, 1
    s_lshl_b32 s60, s56, 7
    s_lshl_b32 s96, s3, 5
    s_add_u32 s60, s60, s96
    s_lshl_b32 s60, s60, 10
    s_mul_i32 s61, s58, 88064
    s_mul_i32 s96, s57, 192
    s_add_u32 s61, s61, s96
    s_lshl_b32 s62, s3, 12
    s_mul_i32 s63, s59, 12288
    s_mul_i32 s96, s58, 6144
    s_add_u32 s63, s63, s96
    s_add_u32 s63, s63, 16384
    v_and_b32 v159, 63, v0
    v_lshrrev_b32 v96, 3, v159
    v_and_b32 v97, 7, v159
    v_lshrrev_b32 v98, 4, v159
    v_xor_b32 v97, v97, v98
    v_lshlrev_b32 v136, 10, v96
    v_lshl_add_u32 v136, v97, 4, v136
    v_xor_b32 v137, 64, v136
    s_movk_i32 s96, 2752
    v_add_u32 v96, 0, v159
    v_mul_u32_u24 v97, 43691, v96
    v_lshrrev_b32 v97, 19, v97
    v_mul_u32_u24 v98, 12, v97
    v_sub_u32 v98, v96, v98
    v_mul_lo_u32 v138, v97, s96
    v_lshl_add_u32 v138, v98, 4, v138
    v_add_u32 v96, 64, v159
    v_mul_u32_u24 v97, 43691, v96
    v_lshrrev_b32 v97, 19, v97
    v_mul_u32_u24 v98, 12, v97
    v_sub_u32 v98, v96, v98
    v_mul_lo_u32 v139, v97, s96
    v_lshl_add_u32 v139, v98, 4, v139
    v_add_u32 v96, 128, v159
    v_mul_u32_u24 v97, 43691, v96
    v_lshrrev_b32 v97, 19, v97
    v_mul_u32_u24 v98, 12, v97
    v_sub_u32 v98, v96, v98
    v_mul_lo_u32 v140, v97, s96
    v_lshl_add_u32 v140, v98, 4, v140
    s_add_u32 s96, s60, 0
    s_add_u32 m0, s62, 0
    s_nop 0
    buffer_load_dwordx4 v136, s[16:19], s96 offen lds
    s_add_u32 s96, s60, 8192
    s_add_u32 m0, s62, 1024
    s_nop 0
    buffer_load_dwordx4 v137, s[16:19], s96 offen lds
    s_add_u32 s96, s60, 16384
    s_add_u32 m0, s62, 2048
    s_nop 0
    buffer_load_dwordx4 v136, s[16:19], s96 offen lds
    s_add_u32 s96, s60, 24576
    s_add_u32 m0, s62, 3072
    s_nop 0
    buffer_load_dwordx4 v137, s[16:19], s96 offen lds
    s_add_u32 s96, s61, 0
    s_add_u32 m0, s63, 0
    s_nop 0
    buffer_load_dwordx4 v138, s[64:67], s96 offen lds
    s_add_u32 s96, s61, 0
    s_add_u32 m0, s63, 1024
    s_nop 0
    buffer_load_dwordx4 v139, s[64:67], s96 offen lds
    s_add_u32 s96, s61, 0
    s_add_u32 m0, s63, 2048
    s_nop 0
    buffer_load_dwordx4 v140, s[64:67], s96 offen lds
    s_add_u32 s96, s61, 44032
    s_add_u32 m0, s63, 3072
    s_nop 0
    buffer_load_dwordx4 v138, s[64:67], s96 offen lds
    s_add_u32 s96, s61, 44032
    s_add_u32 m0, s63, 4096
    s_nop 0
    buffer_load_dwordx4 v139, s[64:67], s96 offen lds
    s_add_u32 s96, s61, 44032
    s_add_u32 m0, s63, 5120
    s_nop 0
    buffer_load_dwordx4 v140, s[64:67], s96 offen lds
    s_lshr_b32 s29, s2, 5
    s_bfe_u32 s31, s2, 0x30002
    s_lshl_b32 s31, s31, 3
    s_add_u32 s29, s29, s31
    s_and_b32 s31, s2, 3
    s_lshl_b32 s31, s31, 6
    s_add_u32 s29, s29, s31
    s_lshr_b32 s31, s3, 1
    s_lshl_b32 s31, s31, 8
    s_add_u32 s29, s29, s31
    s_and_b32 s31, s3, 1
    s_lshl_b32 s31, s31, 10
    s_add_u32 s29, s29, s31
    s_mul_i32 s29, s29, 514
    s_lshl_b32 s31, s3, 11
    s_add_u32 s49, s29, 0
    s_add_u32 m0, s31, 141312
    s_nop 0
    buffer_load_dwordx4 v3, s[36:39], s49 offen lds
    s_add_u32 m0, s31, 149504
    s_nop 0
    buffer_load_dwordx4 v3, s[40:43], s49 offen lds
    s_add_u32 s49, s29, 263168
    s_add_u32 m0, s31, 142336
    s_nop 0
    buffer_load_dwordx4 v3, s[36:39], s49 offen lds
    s_add_u32 m0, s31, 150528
    s_nop 0
    buffer_load_dwordx4 v3, s[40:43], s49 offen lds
    v_and_b32 v96, 31, v159
    v_lshrrev_b32 v97, 5, v159
    v_bfe_u32 v98, v159, 1, 3
    s_lshl_b32 s96, s58, 13
    v_add_u32 v141, 0, v97
    v_xor_b32 v141, v141, v98
    v_lshlrev_b32 v141, 4, v141
    v_lshl_add_u32 v141, v96, 7, v141
    v_add_u32 v141, s96, v141
    v_add_u32 v145, 40960, v141
    v_add_u32 v149, 81920, v141
    v_add_u32 v142, 2, v97
    v_xor_b32 v142, v142, v98
    v_lshlrev_b32 v142, 4, v142
    v_lshl_add_u32 v142, v96, 7, v142
    v_add_u32 v142, s96, v142
    v_add_u32 v146, 40960, v142
    v_add_u32 v150, 81920, v142
    v_add_u32 v143, 4, v97
    v_xor_b32 v143, v143, v98
    v_lshlrev_b32 v143, 4, v143
    v_lshl_add_u32 v143, v96, 7, v143
    v_add_u32 v143, s96, v143
    v_add_u32 v147, 40960, v143
    v_add_u32 v151, 81920, v143
    v_add_u32 v144, 6, v97
    v_xor_b32 v144, v144, v98
    v_lshlrev_b32 v144, 4, v144
    v_lshl_add_u32 v144, v96, 7, v144
    v_add_u32 v144, s96, v144
    v_add_u32 v148, 40960, v144
    v_add_u32 v152, 81920, v144
    v_bfe_u32 v96, v159, 2, 2
    v_lshl_add_u32 v96, v97, 3, v96
    v_mul_u32_u24 v96, 192, v96
    v_and_b32 v97, 3, v159
    v_lshl_add_u32 v96, v97, 3, v96
    s_mul_i32 s96, s59, 96
    v_add_u32 v96, s96, v96
    v_bfe_u32 v97, v159, 4, 1
    v_lshl_add_u32 v153, v97, 5, v96
    v_mul_u32_u24 v97, 12288, v97
    v_add3_u32 v156, v96, v97, 64
    v_add_u32 v154, 40960, v153
    v_add_u32 v157, 40960, v156
    v_add_u32 v155, 81920, v153
    v_add_u32 v158, 81920, v156
    v_mul_u32_u24 v3, 4608, v2
    v_add_u32 v3, 122880, v3
    v_lshl_add_u32 v4, v1, 3, v3
    v_lshrrev_b32 v7, 3, v1
    v_and_b32 v8, 7, v1
    v_mul_u32_u24 v7, 72, v7
    v_add_u32 v5, v7, v8
    v_lshl_add_u32 v5, v5, 3, v3
    v_mul_u32_u24 v6, 9, v8
    v_add_u32 v6, v6, v7
    v_and_b32 v88, 63, v0
    v_lshlrev_b32 v89, 4, v88
    s_bfe_u32 s98, s4, 0x10002
    v_lshl_add_u32 v6, v6, 3, v3
    v_cvt_f32_u32 v9, v1
    v_mul_f32 v11, 0x3b000000, v9
    v_fract_f32 v11, v11
    v_cos_f32 v10, v11
    v_sin_f32 v11, v11
    v_mul_f32 v13, 0x3b800000, v9
    v_fract_f32 v13, v13
    v_cos_f32 v12, v13
    v_sin_f32 v13, v13
    s_lshl_b32 s98, s98, 10
    s_lshr_b32 s99, s4, 3
    s_lshl_b32 s99, s99, 5
    v_mul_f32 v15, 0x3bc00000, v9
    v_fract_f32 v15, v15
    v_cos_f32 v14, v15
    v_sin_f32 v15, v15
    v_mul_f32 v17, 0x3c000000, v9
    v_fract_f32 v17, v17
    v_cos_f32 v16, v17
    v_sin_f32 v17, v17
    v_mul_f32 v19, 0x3c200000, v9
    v_fract_f32 v19, v19
    s_add_u32 s98, s98, s99
    s_lshl_b32 s99, s3, 3
    s_add_u32 s98, s98, s99
    v_cos_f32 v18, v19
    v_sin_f32 v19, v19
    v_mul_f32 v21, 0x3c400000, v9
    v_fract_f32 v21, v21
    v_cos_f32 v20, v21
    v_sin_f32 v21, v21
    v_mul_f32 v23, 0x3c600000, v9
    v_fract_f32 v23, v23
    v_cos_f32 v22, v23
    v_sin_f32 v23, v23
    s_lshl_b32 s98, s98, 10
    s_add_u32 s99, s98, 0
    buffer_load_dwordx4 v[92:95], v89, s[16:19], s99 offen
    v_cvt_f32_u32 v9, v8
    v_mul_f32 v25, 0x3c800000, v9
    v_fract_f32 v25, v25
    v_cos_f32 v24, v25
    v_sin_f32 v25, v25
    v_mul_f32 v27, 0x3d000000, v9
    v_fract_f32 v27, v27
    v_cos_f32 v26, v27
    v_sin_f32 v27, v27
    v_mul_f32 v29, 0x3d400000, v9
    s_add_u32 s99, s98, 1024
    buffer_load_dwordx4 v[92:95], v89, s[16:19], s99 offen
    s_add_u32 s99, s98, 2048
    v_fract_f32 v29, v29
    v_cos_f32 v28, v29
    v_sin_f32 v29, v29
    v_mul_f32 v31, 0x3d800000, v9
    v_fract_f32 v31, v31
    v_cos_f32 v30, v31
    v_sin_f32 v31, v31
    v_mul_f32 v33, 0x3da00000, v9
    v_fract_f32 v33, v33
    v_cos_f32 v32, v33
    buffer_load_dwordx4 v[92:95], v89, s[16:19], s99 offen
    s_add_u32 s99, s98, 3072
    buffer_load_dwordx4 v[92:95], v89, s[16:19], s99 offen
    v_sin_f32 v33, v33
    v_mul_f32 v35, 0x3dc00000, v9
    v_fract_f32 v35, v35
    v_cos_f32 v34, v35
    v_sin_f32 v35, v35
    v_mul_f32 v37, 0x3de00000, v9
    v_fract_f32 v37, v37
    v_cos_f32 v36, v37
    v_sin_f32 v37, v37
    v_mov_b32 v8, 0
    s_add_u32 s99, s98, 4096
    buffer_load_dwordx4 v[92:95], v89, s[16:19], s99 offen
    s_add_u32 s99, s98, 5120
    v_mov_b32 v9, 0
    v_mov_b32 v7, 0
    v_mov_b32 v38, 0
    v_mov_b32 v39, 0
    v_mov_b32 v52, 0
    v_mov_b32 v40, 0
    v_mov_b32 v41, 0
    v_mov_b32 v53, 0
    v_mov_b32 v42, 0
    v_mov_b32 v43, 0
    buffer_load_dwordx4 v[92:95], v89, s[16:19], s99 offen
    s_add_u32 s99, s98, 6144
    buffer_load_dwordx4 v[92:95], v89, s[16:19], s99 offen
    v_mov_b32 v54, 0
    v_mov_b32 v44, 0
    v_mov_b32 v45, 0
    v_mov_b32 v55, 0
    v_mov_b32 v46, 0
    v_mov_b32 v47, 0
    v_mov_b32 v56, 0
    v_mov_b32 v48, 0
    v_mov_b32 v49, 0
    v_mov_b32 v57, 0
    s_add_u32 s99, s98, 7168
    buffer_load_dwordx4 v[92:95], v89, s[16:19], s99 offen
    s_lshr_b32 s98, s4, 3
    v_mov_b32 v50, 0
    v_mov_b32 v51, 0
    v_mov_b32 v58, 0
    v_lshl_add_u32 v59, v1, 1, v3
    s_lshl_b32 s98, s98, 4
    s_and_b32 s99, s3, 1
    s_lshl_b32 s99, s99, 3
    v_mov_b32 v160, 0
    v_mov_b32 v161, 0
    v_mov_b32 v162, 0
    v_mov_b32 v163, 0
    v_mov_b32 v164, 0
    v_mov_b32 v165, 0
    v_mov_b32 v166, 0
    v_mov_b32 v167, 0
    v_mov_b32 v168, 0
    v_mov_b32 v169, 0
    v_mov_b32 v170, 0
    v_mov_b32 v171, 0
    v_mov_b32 v172, 0
    v_mov_b32 v173, 0
    v_mov_b32 v174, 0
    v_mov_b32 v175, 0
    v_mov_b32 v176, 0
    v_mov_b32 v177, 0
    v_mov_b32 v178, 0
    v_mov_b32 v179, 0
    v_mov_b32 v180, 0
    v_mov_b32 v181, 0
    v_mov_b32 v182, 0
    v_mov_b32 v183, 0
    v_mov_b32 v184, 0
    v_mov_b32 v185, 0
    v_mov_b32 v186, 0
    v_mov_b32 v187, 0
    v_mov_b32 v188, 0
    v_mov_b32 v189, 0
    v_mov_b32 v190, 0
    v_mov_b32 v191, 0
    v_mov_b32 v192, 0
    v_mov_b32 v193, 0
    v_mov_b32 v194, 0
    v_mov_b32 v195, 0
    v_mov_b32 v196, 0
    v_mov_b32 v197, 0
    v_mov_b32 v198, 0
    v_mov_b32 v199, 0
    v_mov_b32 v200, 0
    v_mov_b32 v201, 0
    v_mov_b32 v202, 0
    v_mov_b32 v203, 0
    v_mov_b32 v204, 0
    v_mov_b32 v205, 0
    v_mov_b32 v206, 0
    v_mov_b32 v207, 0
    v_mov_b32 v208, 0
    v_mov_b32 v209, 0
    v_mov_b32 v210, 0
    v_mov_b32 v211, 0
    v_mov_b32 v212, 0
    v_mov_b32 v213, 0
    v_mov_b32 v214, 0
    v_mov_b32 v215, 0
    v_mov_b32 v216, 0
    v_mov_b32 v217, 0
    v_mov_b32 v218, 0
    v_mov_b32 v219, 0
    v_mov_b32 v220, 0
    v_mov_b32 v221, 0
    v_mov_b32 v222, 0
    v_mov_b32 v223, 0
    v_mov_b32 v224, 0
    v_mov_b32 v225, 0
    v_mov_b32 v226, 0
    v_mov_b32 v227, 0
    v_mov_b32 v228, 0
    v_mov_b32 v229, 0
    v_mov_b32 v230, 0
    v_mov_b32 v231, 0
    v_mov_b32 v232, 0
    v_mov_b32 v233, 0
    v_mov_b32 v234, 0
    v_mov_b32 v235, 0
    v_mov_b32 v236, 0
    v_mov_b32 v237, 0
    v_mov_b32 v238, 0
    v_mov_b32 v239, 0
    v_mov_b32 v240, 0
    v_mov_b32 v241, 0
    v_mov_b32 v242, 0
    v_mov_b32 v243, 0
    v_mov_b32 v244, 0
    v_mov_b32 v245, 0
    v_mov_b32 v246, 0
    v_mov_b32 v247, 0
    v_mov_b32 v248, 0
    v_mov_b32 v249, 0
    v_mov_b32 v250, 0
    v_mov_b32 v251, 0
    v_mov_b32 v252, 0
    v_mov_b32 v253, 0
    v_mov_b32 v254, 0
    v_mov_b32 v255, 0
    s_waitcnt vmcnt(22)
    ds_read_u16_d16_hi v8, v59 offset:0
    ds_read_u16_d16_hi v9, v59 offset:1024
    ds_read_u16_d16_hi v7, v59 offset:2048
    ds_read_u16_d16_hi v38, v59 offset:128
    ds_read_u16_d16_hi v39, v59 offset:1152
    ds_read_u16_d16_hi v52, v59 offset:2176
    ds_read_u16_d16_hi v40, v59 offset:256
    ds_read_u16_d16_hi v41, v59 offset:1280
    ds_read_u16_d16_hi v53, v59 offset:2304
    ds_read_u16_d16_hi v42, v59 offset:384
    s_add_u32 s98, s98, s99
    s_mul_i32 s98, s98, 2752
    s_and_b32 s99, s4, 3
    ds_read_u16_d16_hi v43, v59 offset:1408
    ds_read_u16_d16_hi v54, v59 offset:2432
    ds_read_u16_d16_hi v44, v59 offset:512
    ds_read_u16_d16_hi v45, v59 offset:1536
    ds_read_u16_d16_hi v55, v59 offset:2560
    ds_read_u16_d16_hi v46, v59 offset:640
    ds_read_u16_d16_hi v47, v59 offset:1664
    ds_read_u16_d16_hi v56, v59 offset:2688
    ds_read_u16_d16_hi v48, v59 offset:768
    ds_read_u16_d16_hi v49, v59 offset:1792
    s_mul_i32 s99, s99, 768
    s_add_u32 s98, s98, s99
    s_movk_i32 s99, 2752
    ds_read_u16_d16_hi v57, v59 offset:2816
    ds_read_u16_d16_hi v50, v59 offset:896
    ds_read_u16_d16_hi v51, v59 offset:1920
    ds_read_u16_d16_hi v58, v59 offset:2944
    s_waitcnt lgkmcnt(0)
    v_mul_f32 v61, v8, v7
    v_mul_f32 v62, v9, v7
    v_cvt_pk_bf16_f32 v63, v61, v62
    v_lshlrev_b32 v61, 16, v63
    v_and_b32 v62, 0xffff0000, v63
    v_add_u32 v90, 0, v88
    v_mul_u32_u24 v91, 21846, v90
    v_lshrrev_b32 v91, 20, v91
    v_mov_b32 v59, v61
    v_mov_b32 v60, v62
    v_mul_f32 v61, v38, v52
    v_mul_f32 v62, v39, v52
    v_cvt_pk_bf16_f32 v63, v61, v62
    v_lshlrev_b32 v61, 16, v63
    v_and_b32 v62, 0xffff0000, v63
    v_add_f32 v59, v59, v61
    v_add_f32 v60, v60, v62
    v_mul_f32 v61, v40, v53
    v_mul_u32_u24 v89, 48, v91
    v_sub_u32 v90, v90, v89
    v_mul_lo_u32 v91, v91, s99
    v_mul_f32 v62, v41, v53
    v_cvt_pk_bf16_f32 v63, v61, v62
    v_lshlrev_b32 v61, 16, v63
    v_and_b32 v62, 0xffff0000, v63
    v_add_f32 v59, v59, v61
    v_add_f32 v60, v60, v62
    v_mul_f32 v61, v42, v54
    v_mul_f32 v62, v43, v54
    v_cvt_pk_bf16_f32 v63, v61, v62
    v_lshlrev_b32 v61, 16, v63
    v_lshl_add_u32 v91, v90, 4, v91
    buffer_load_dwordx4 v[92:95], v91, s[64:67], s98 offen
    v_add_u32 v90, 64, v88
    v_and_b32 v62, 0xffff0000, v63
    v_add_f32 v59, v59, v61
    v_add_f32 v60, v60, v62
    v_mul_f32 v61, v44, v55
    v_mul_f32 v62, v45, v55
    v_cvt_pk_bf16_f32 v63, v61, v62
    v_lshlrev_b32 v61, 16, v63
    v_and_b32 v62, 0xffff0000, v63
    v_add_f32 v59, v59, v61
    v_add_f32 v60, v60, v62
    v_mul_u32_u24 v91, 21846, v90
    v_lshrrev_b32 v91, 20, v91
    v_mul_u32_u24 v89, 48, v91
    v_mul_f32 v61, v46, v56
    v_mul_f32 v62, v47, v56
    v_cvt_pk_bf16_f32 v63, v61, v62
    v_lshlrev_b32 v61, 16, v63
    v_and_b32 v62, 0xffff0000, v63
    v_add_f32 v59, v59, v61
    v_add_f32 v60, v60, v62
    v_mul_f32 v61, v48, v57
    v_mul_f32 v62, v49, v57
    v_cvt_pk_bf16_f32 v63, v61, v62
    v_sub_u32 v90, v90, v89
    v_mul_lo_u32 v91, v91, s99
    v_lshl_add_u32 v91, v90, 4, v91
    v_lshlrev_b32 v61, 16, v63
    v_and_b32 v62, 0xffff0000, v63
    v_add_f32 v59, v59, v61
    v_add_f32 v60, v60, v62
    v_mul_f32 v61, v50, v58
    v_mul_f32 v62, v51, v58
    v_cvt_pk_bf16_f32 v63, v61, v62
    v_lshlrev_b32 v61, 16, v63
    v_and_b32 v62, 0xffff0000, v63
    v_add_f32 v59, v59, v61
    buffer_load_dwordx4 v[92:95], v91, s[64:67], s98 offen
    v_add_u32 v90, 128, v88
    v_mul_u32_u24 v91, 21846, v90
    v_add_f32 v60, v60, v62
    v_add_f32_dpp v59, v59, v59 row_shr:1 row_mask:0xf bank_mask:0xf bound_ctrl:0
    s_nop 0
    v_add_f32_dpp v60, v60, v60 row_shr:1 row_mask:0xf bank_mask:0xf bound_ctrl:0
    v_add_f32_dpp v59, v59, v59 row_shr:2 row_mask:0xf bank_mask:0xf bound_ctrl:0
    s_nop 0
    v_add_f32_dpp v60, v60, v60 row_shr:2 row_mask:0xf bank_mask:0xf bound_ctrl:0
    v_add_f32_dpp v59, v59, v59 row_shr:4 row_mask:0xf bank_mask:0xf bound_ctrl:0
    s_nop 0
    v_add_f32_dpp v60, v60, v60 row_shr:4 row_mask:0xf bank_mask:0xf bound_ctrl:0
    v_add_f32_dpp v59, v59, v59 row_shr:8 row_mask:0xf bank_mask:0xf bound_ctrl:0
    s_nop 0
    v_add_f32_dpp v60, v60, v60 row_shr:8 row_mask:0xf bank_mask:0xf bound_ctrl:0
    v_add_f32_dpp v59, v59, v59 row_bcast:15 row_mask:0xa bank_mask:0xf
    v_lshrrev_b32 v91, 20, v91
    v_mul_u32_u24 v89, 48, v91
    v_sub_u32 v90, v90, v89
    v_add_f32_dpp v60, v60, v60 row_bcast:15 row_mask:0xa bank_mask:0xf
    v_add_f32_dpp v59, v59, v59 row_bcast:31 row_mask:0xc bank_mask:0xf
    s_nop 0
    v_add_f32_dpp v60, v60, v60 row_bcast:31 row_mask:0xc bank_mask:0xf
    v_cvt_pk_bf16_f32 v63, v59, v60
    v_lshlrev_b32 v61, 16, v63
    v_and_b32 v62, 0xffff0000, v63
    v_mul_f32 v61, 0xbfb8aa3b, v61
    v_mul_f32 v62, 0xbfb8aa3b, v62
    v_exp_f32 v61, v61
    v_exp_f32 v62, v62
    v_mul_lo_u32 v91, v91, s99
    v_lshl_add_u32 v91, v90, 4, v91
    buffer_load_dwordx4 v[92:95], v91, s[64:67], s98 offen
    v_add_f32 v61, 1.0, v61
    v_add_f32 v62, 1.0, v62
    v_rcp_f32 v61, v61
    v_rcp_f32 v62, v62
    s_nop 0
    v_cvt_pk_bf16_f32 v63, v61, v62
    v_lshlrev_b32 v52, 16, v63
    v_and_b32 v53, 0xffff0000, v63
    v_mov_b32 v61, 0
    s_lshl_b32 s31, s14, 2
    s_mov_b32 exec_lo, 0
    s_mov_b32 exec_hi, 0x80000000
    buffer_store_dwordx2 v[52:53], v61, s[32:35], s31 offen
    s_mov_b64 exec, -1
    v_add_u32 v90, 192, v88
    v_mul_u32_u24 v91, 21846, v90
    v_lshrrev_b32 v91, 20, v91
    v_add_f32 v52, v8, v44
    v_add_f32 v53, v9, v45
    v_sub_f32 v54, v8, v44
    v_sub_f32 v55, v9, v45
    v_add_f32 v8, v38, v46
    v_add_f32 v9, v39, v47
    v_sub_f32 v44, v38, v46
    v_sub_f32 v45, v39, v47
    v_add_f32 v38, v40, v48
    v_add_f32 v39, v41, v49
    v_mul_u32_u24 v89, 48, v91
    v_sub_u32 v90, v90, v89
    v_mul_lo_u32 v91, v91, s99
    v_sub_f32 v46, v40, v48
    v_sub_f32 v47, v41, v49
    v_add_f32 v40, v42, v50
    v_add_f32 v41, v43, v51
    v_sub_f32 v48, v42, v50
    v_sub_f32 v49, v43, v51
    v_add_f32 v42, v44, v45
    v_sub_f32 v43, v45, v44
    v_sub_f32 v50, v49, v48
    v_add_f32 v51, v49, v48
    v_lshl_add_u32 v91, v90, 4, v91
    buffer_load_dwordx4 v[92:95], v91, s[64:67], s98 offen
    v_add_u32 v90, 256, v88
    v_add_f32 v44, v52, v38
    v_add_f32 v45, v53, v39
    v_sub_f32 v48, v52, v38
    v_sub_f32 v49, v53, v39
    v_add_f32 v56, v8, v40
    v_add_f32 v57, v9, v41
    v_sub_f32 v58, v8, v40
    v_sub_f32 v59, v9, v41
    v_add_f32 v8, v54, v47
    v_sub_f32 v9, v55, v46
    v_mul_u32_u24 v91, 21846, v90
    v_lshrrev_b32 v91, 20, v91
    v_mul_u32_u24 v89, 48, v91
    v_sub_f32 v38, v54, v47
    v_add_f32 v39, v55, v46
    v_add_f32 v40, v42, v50
    v_sub_f32 v41, v43, v51
    v_sub_f32 v46, v42, v50
    v_add_f32 v47, v43, v51
    v_add_f32 v42, v44, v56
    v_add_f32 v43, v45, v57
    v_sub_f32 v50, v44, v56
    v_sub_f32 v51, v45, v57
    v_sub_u32 v90, v90, v89
    v_mul_lo_u32 v91, v91, s99
    v_lshl_add_u32 v91, v90, 4, v91
    v_add_f32 v52, v48, v59
    v_sub_f32 v53, v49, v58
    v_sub_f32 v54, v48, v59
    v_add_f32 v55, v49, v58
    v_fma_f32 v60, v40, s30, v8
    v_fma_f32 v61, v41, s30, v9
    v_fma_f32 v62, -v40, s30, v8
    v_fma_f32 v63, -v41, s30, v9
    v_fma_f32 v64, v47, s30, v38
    v_fma_f32 v65, -v46, s30, v39
    buffer_load_dwordx4 v[92:95], v91, s[64:67], s98 offen
    v_add_u32 v90, 320, v88
    v_mul_u32_u24 v91, 21846, v90
    v_fma_f32 v66, -v47, s30, v38
    v_fma_f32 v67, v46, s30, v39
    ds_write_b64 v4, v[42:43] offset:0
    v_mul_f32_e64 v8, v60, v10
    v_mul_f32_e64 v9, v60, -v11
    v_fma_f32 v8, -v61, -v11, v8
    v_fma_f32 v9, v61, v10, v9
    ds_write_b64 v4, v[8:9] offset:576
    v_mul_f32_e64 v8, v52, v12
    v_mul_f32_e64 v9, v52, -v13
    v_lshrrev_b32 v91, 20, v91
    v_mul_u32_u24 v89, 48, v91
    v_sub_u32 v90, v90, v89
    v_fma_f32 v8, -v53, -v13, v8
    v_fma_f32 v9, v53, v12, v9
    ds_write_b64 v4, v[8:9] offset:1152
    v_mul_f32_e64 v8, v64, v14
    v_mul_f32_e64 v9, v64, -v15
    v_fma_f32 v8, -v65, -v15, v8
    v_fma_f32 v9, v65, v14, v9
    ds_write_b64 v4, v[8:9] offset:1728
    v_mul_f32_e64 v8, v50, v16
    v_mul_f32_e64 v9, v50, -v17
    v_mul_lo_u32 v91, v91, s99
    v_lshl_add_u32 v91, v90, 4, v91
    buffer_load_dwordx4 v[92:95], v91, s[64:67], s98 offen
    v_fma_f32 v8, -v51, -v17, v8
    v_fma_f32 v9, v51, v16, v9
    ds_write_b64 v4, v[8:9] offset:2304
    v_mul_f32_e64 v8, v62, v18
    v_mul_f32_e64 v9, v62, -v19
    v_fma_f32 v8, -v63, -v19, v8
    v_fma_f32 v9, v63, v18, v9
    ds_write_b64 v4, v[8:9] offset:2880
    v_mul_f32_e64 v8, v54, v20
    v_mul_f32_e64 v9, v54, -v21
    s_add_u32 s96, s60, 128
    s_add_u32 m0, s62, 40960
    s_nop 0
    buffer_load_dwordx4 v136, s[16:19], s96 offen lds
    v_fma_f32 v8, -v55, -v21, v8
    v_fma_f32 v9, v55, v20, v9
    ds_write_b64 v4, v[8:9] offset:3456
    v_mul_f32_e64 v8, v66, v22
    v_mul_f32_e64 v9, v66, -v23
    v_fma_f32 v8, -v67, -v23, v8
    v_fma_f32 v9, v67, v22, v9
    ds_write_b64 v4, v[8:9] offset:4032
    s_waitcnt vmcnt(16)
    s_add_u32 s96, s60, 8320
    s_add_u32 m0, s62, 41984
    s_nop 0
    buffer_load_dwordx4 v137, s[16:19], s96 offen lds
    s_waitcnt lgkmcnt(0)
    s_barrier
    ds_read_b128 v[96:99], v141 offset:0
    ds_read_b64_tr_b16 v[112:113], v153 offset:16384
    ds_read_b64_tr_b16 v[114:115], v153 offset:17152
    ds_read_b64_tr_b16 v[116:117], v153 offset:28672
    ds_read_b64_tr_b16 v[118:119], v153 offset:29440
    ds_read_b64_tr_b16 v[120:121], v156 offset:16384
    ds_read_b64_tr_b16 v[122:123], v156 offset:17152
    ds_read_b128 v[100:103], v141 offset:4096
    s_waitcnt lgkmcnt(5)
    v_mfma_f32_32x32x16_bf16 v[160:175], v[112:115], v[96:99], v[160:175]
    ds_read_b128 v[104:107], v142 offset:0
    ds_read_b64_tr_b16 v[124:125], v153 offset:19456
    s_add_u32 s96, s60, 16512
    s_add_u32 m0, s62, 43008
    s_nop 0
    buffer_load_dwordx4 v136, s[16:19], s96 offen lds
    v_lshlrev_b32 v39, 1, v0
    s_waitcnt lgkmcnt(5)
    v_mfma_f32_32x32x16_bf16 v[176:191], v[116:119], v[96:99], v[176:191]
    ds_read_b64_tr_b16 v[126:127], v153 offset:20224
    ds_read_b64_tr_b16 v[128:129], v153 offset:31744
    s_add_u32 s96, s60, 24704
    s_add_u32 m0, s62, 44032
    s_nop 0
    buffer_load_dwordx4 v137, s[16:19], s96 offen lds
    v_add_u32 v39, 141312, v39
    s_waitcnt lgkmcnt(5)
    v_mfma_f32_32x32x16_bf16 v[192:207], v[120:123], v[96:99], v[192:207]
    ds_read_b64_tr_b16 v[130:131], v153 offset:32512
    ds_read_b64_tr_b16 v[132:133], v156 offset:19456
    s_add_u32 s96, s61, 176128
    s_add_u32 m0, s63, 40960
    s_nop 0
    buffer_load_dwordx4 v138, s[64:67], s96 offen lds
    ds_read_u16 v7, v39 offset:0
    s_waitcnt lgkmcnt(7)
    v_mfma_f32_32x32x16_bf16 v[208:223], v[112:115], v[100:103], v[208:223]
    ds_read_b64_tr_b16 v[134:135], v156 offset:20224
    ds_read_b128 v[108:111], v142 offset:4096
    s_add_u32 s96, s61, 176128
    s_add_u32 m0, s63, 41984
    s_nop 0
    buffer_load_dwordx4 v139, s[64:67], s96 offen lds
    ds_read_u16 v16, v39 offset:8192
    v_mfma_f32_32x32x16_bf16 v[224:239], v[116:119], v[100:103], v[224:239]
    s_add_u32 s96, s61, 176128
    s_add_u32 m0, s63, 43008
    s_nop 0
    buffer_load_dwordx4 v140, s[64:67], s96 offen lds
    ds_read_u16 v8, v39 offset:1024
    ds_read_u16 v17, v39 offset:9216
    ds_read_u16 v9, v39 offset:2048
    v_mfma_f32_32x32x16_bf16 v[240:255], v[120:123], v[100:103], v[240:255]
    s_add_u32 s96, s61, 220160
    s_add_u32 m0, s63, 44032
    s_nop 0
    buffer_load_dwordx4 v138, s[64:67], s96 offen lds
    ds_read_u16 v18, v39 offset:10240
    ds_read_u16 v10, v39 offset:3072
    ds_read_u16 v19, v39 offset:11264
    s_waitcnt lgkmcnt(13)
    v_mfma_f32_32x32x16_bf16 v[160:175], v[124:127], v[104:107], v[160:175]
    ds_read_b128 v[96:99], v143 offset:0
    ds_read_b64_tr_b16 v[112:113], v153 offset:22528
    s_add_u32 s96, s61, 220160
    s_add_u32 m0, s63, 45056
    s_nop 0
    buffer_load_dwordx4 v139, s[64:67], s96 offen lds
    ds_read_u16 v11, v39 offset:4096
    s_waitcnt lgkmcnt(14)
    v_mfma_f32_32x32x16_bf16 v[176:191], v[128:131], v[104:107], v[176:191]
    ds_read_b64_tr_b16 v[114:115], v153 offset:23296
    ds_read_b64_tr_b16 v[116:117], v153 offset:34816
    s_add_u32 s96, s61, 220160
    s_add_u32 m0, s63, 46080
    s_nop 0
    buffer_load_dwordx4 v140, s[64:67], s96 offen lds
    ds_read_u16 v20, v39 offset:12288
    s_waitcnt lgkmcnt(14)
    v_mfma_f32_32x32x16_bf16 v[192:207], v[132:135], v[104:107], v[192:207]
    ds_read_b64_tr_b16 v[118:119], v153 offset:35584
    ds_read_b64_tr_b16 v[120:121], v156 offset:22528
    s_add_u32 s96, s60, 256
    s_add_u32 m0, s62, 81920
    s_nop 0
    buffer_load_dwordx4 v136, s[16:19], s96 offen lds
    ds_read_u16 v12, v39 offset:5120
    s_waitcnt lgkmcnt(15)
    v_mfma_f32_32x32x16_bf16 v[208:223], v[124:127], v[108:111], v[208:223]
    ds_read_b64_tr_b16 v[122:123], v156 offset:23296
    ds_read_b128 v[100:103], v143 offset:4096
    s_add_u32 s96, s60, 8448
    s_add_u32 m0, s62, 82944
    s_nop 0
    buffer_load_dwordx4 v137, s[16:19], s96 offen lds
    ds_read_u16 v21, v39 offset:13312
    v_mfma_f32_32x32x16_bf16 v[224:239], v[128:131], v[108:111], v[224:239]
    s_add_u32 s96, s60, 16640
    s_add_u32 m0, s62, 83968
    s_nop 0
    buffer_load_dwordx4 v136, s[16:19], s96 offen lds
    ds_read_u16 v13, v39 offset:6144
    ds_read_u16 v22, v39 offset:14336
    ds_read_u16 v14, v39 offset:7168
    v_mfma_f32_32x32x16_bf16 v[240:255], v[132:135], v[108:111], v[240:255]
    s_add_u32 s96, s60, 24832
    s_add_u32 m0, s62, 84992
    s_nop 0
    buffer_load_dwordx4 v137, s[16:19], s96 offen lds
    ds_read_u16 v23, v39 offset:15360
    v_and_b32 v40, 7, v0
    v_lshlrev_b32 v40, 10, v40
    s_waitcnt lgkmcnt(12)
    v_mfma_f32_32x32x16_bf16 v[160:175], v[112:115], v[96:99], v[160:175]
    ds_read_b128 v[104:107], v144 offset:0
    ds_read_b64_tr_b16 v[124:125], v153 offset:25600
    s_add_u32 s96, s61, 352256
    s_add_u32 m0, s63, 81920
    s_nop 0
    buffer_load_dwordx4 v138, s[64:67], s96 offen lds
    v_add_u32 v40, 141824, v40
    s_waitcnt lgkmcnt(11)
    v_mfma_f32_32x32x16_bf16 v[176:191], v[116:119], v[96:99], v[176:191]
    ds_read_b64_tr_b16 v[126:127], v153 offset:26368
    ds_read_b64_tr_b16 v[128:129], v153 offset:37888
    s_add_u32 s96, s61, 352256
    s_add_u32 m0, s63, 82944
    s_nop 0
    buffer_load_dwordx4 v139, s[64:67], s96 offen lds
    ds_read_u16 v15, v40
    s_waitcnt lgkmcnt(11)
    v_mfma_f32_32x32x16_bf16 v[192:207], v[120:123], v[96:99], v[192:207]
    ds_read_b64_tr_b16 v[130:131], v153 offset:38656
    ds_read_b64_tr_b16 v[132:133], v156 offset:25600
    s_add_u32 s96, s61, 352256
    s_add_u32 m0, s63, 83968
    s_nop 0
    buffer_load_dwordx4 v140, s[64:67], s96 offen lds
    ds_read_u16 v38, v40 offset:8192
    s_waitcnt lgkmcnt(13)
    v_mfma_f32_32x32x16_bf16 v[208:223], v[112:115], v[100:103], v[208:223]
    ds_read_b64_tr_b16 v[134:135], v156 offset:26368
    ds_read_b128 v[108:111], v144 offset:4096
    s_add_u32 s96, s61, 396288
    s_add_u32 m0, s63, 84992
    s_nop 0
    buffer_load_dwordx4 v138, s[64:67], s96 offen lds
    s_waitcnt lgkmcnt(0)
    v_mfma_f32_32x32x16_bf16 v[224:239], v[116:119], v[100:103], v[224:239]
    s_add_u32 s96, s61, 396288
    s_add_u32 m0, s63, 86016
    s_nop 0
    buffer_load_dwordx4 v139, s[64:67], s96 offen lds
    v_lshl_or_b32 v16, v16, 16, v7
    v_lshl_or_b32 v17, v17, 16, v8
    v_lshl_or_b32 v18, v18, 16, v9
    v_mfma_f32_32x32x16_bf16 v[240:255], v[120:123], v[100:103], v[240:255]
    s_add_u32 s96, s61, 396288
    s_add_u32 m0, s63, 87040
    s_nop 0
    buffer_load_dwordx4 v140, s[64:67], s96 offen lds
    v_lshl_or_b32 v19, v19, 16, v10
    v_lshl_or_b32 v20, v20, 16, v11
    v_lshl_or_b32 v21, v21, 16, v12
    v_lshl_or_b32 v22, v22, 16, v13
    v_lshl_or_b32 v23, v23, 16, v14
    v_lshl_or_b32 v15, v38, 16, v15
    s_movk_i32 s31, 8448
    v_mul_lo_u32 v40, v0, s31
    s_lshl_b32 s31, s2, 5
    buffer_store_dwordx4 v[16:19], v40, s[44:47], s31 offen
    buffer_store_dwordx4 v[20:23], v40, s[44:47], s31 offen offset:16
    v_cmp_gt_u32 vcc, 8, v0
    s_nop 0
    s_and_saveexec_b64 s[48:49], vcc
    s_cbranch_execz K1W256_1
    v_lshlrev_b32 v39, 2, v0
    s_add_u32 s31, s31, 0x210000
    buffer_store_dword v15, v39, s[44:47], s31 offen
K1W256_1:
    s_mov_b64 exec, -1
    s_waitcnt lgkmcnt(0)
    ds_read_b64 v[8:9], v5 offset:0
    ds_read_b64 v[10:11], v5 offset:64
    ds_read_b64 v[12:13], v5 offset:128
    ds_read_b64 v[14:15], v5 offset:192
    ds_read_b64 v[16:17], v5 offset:256
    ds_read_b64 v[18:19], v5 offset:320
    ds_read_b64 v[20:21], v5 offset:384
    ds_read_b64 v[22:23], v5 offset:448
    s_waitcnt lgkmcnt(0)
    v_add_f32 v38, v8, v16
    v_add_f32 v39, v9, v17
    v_sub_f32 v40, v8, v16
    v_sub_f32 v41, v9, v17
    v_add_f32 v8, v10, v18
    v_add_f32 v9, v11, v19
    v_sub_f32 v16, v10, v18
    v_sub_f32 v17, v11, v19
    v_add_f32 v10, v12, v20
    v_add_f32 v11, v13, v21
    v_sub_f32 v18, v12, v20
    v_sub_f32 v19, v13, v21
    v_add_f32 v12, v14, v22
    v_add_f32 v13, v15, v23
    v_sub_f32 v20, v14, v22
    v_sub_f32 v21, v15, v23
    v_add_f32 v14, v16, v17
    v_sub_f32 v15, v17, v16
    v_sub_f32 v22, v21, v20
    v_add_f32 v23, v21, v20
    v_add_f32 v16, v38, v10
    v_add_f32 v17, v39, v11
    v_sub_f32 v20, v38, v10
    v_sub_f32 v21, v39, v11
    v_add_f32 v42, v8, v12
    v_add_f32 v43, v9, v13
    v_sub_f32 v44, v8, v12
    v_sub_f32 v45, v9, v13
    v_add_f32 v8, v40, v19
    v_sub_f32 v9, v41, v18
    v_sub_f32 v10, v40, v19
    v_add_f32 v11, v41, v18
    v_add_f32 v12, v14, v22
    v_sub_f32 v13, v15, v23
    v_sub_f32 v18, v14, v22
    v_add_f32 v19, v15, v23
    v_add_f32 v14, v16, v42
    v_add_f32 v15, v17, v43
    v_sub_f32 v22, v16, v42
    v_sub_f32 v23, v17, v43
    v_add_f32 v38, v20, v45
    v_sub_f32 v39, v21, v44
    v_sub_f32 v40, v20, v45
    v_add_f32 v41, v21, v44
    v_fma_f32 v46, v12, s30, v8
    v_fma_f32 v47, v13, s30, v9
    v_fma_f32 v48, -v12, s30, v8
    v_fma_f32 v49, -v13, s30, v9
    v_fma_f32 v50, v19, s30, v10
    v_fma_f32 v51, -v18, s30, v11
    v_fma_f32 v52, -v19, s30, v10
    v_fma_f32 v53, v18, s30, v11
    ds_write_b64 v5, v[14:15] offset:0
    v_mul_f32_e64 v8, v46, v24
    v_mul_f32_e64 v9, v46, -v25
    v_fma_f32 v8, -v47, -v25, v8
    v_fma_f32 v9, v47, v24, v9
    ds_write_b64 v5, v[8:9] offset:72
    v_mul_f32_e64 v8, v38, v26
    v_mul_f32_e64 v9, v38, -v27
    v_fma_f32 v8, -v39, -v27, v8
    v_fma_f32 v9, v39, v26, v9
    ds_write_b64 v5, v[8:9] offset:144
    v_mul_f32_e64 v8, v50, v28
    v_mul_f32_e64 v9, v50, -v29
    v_fma_f32 v8, -v51, -v29, v8
    v_fma_f32 v9, v51, v28, v9
    ds_write_b64 v5, v[8:9] offset:216
    v_mul_f32_e64 v8, v22, v30
    v_mul_f32_e64 v9, v22, -v31
    v_fma_f32 v8, -v23, -v31, v8
    v_fma_f32 v9, v23, v30, v9
    ds_write_b64 v5, v[8:9] offset:288
    v_mul_f32_e64 v8, v48, v32
    v_mul_f32_e64 v9, v48, -v33
    v_fma_f32 v8, -v49, -v33, v8
    v_fma_f32 v9, v49, v32, v9
    ds_write_b64 v5, v[8:9] offset:360
    v_mul_f32_e64 v8, v40, v34
    v_mul_f32_e64 v9, v40, -v35
    v_fma_f32 v8, -v41, -v35, v8
    v_fma_f32 v9, v41, v34, v9
    ds_write_b64 v5, v[8:9] offset:432
    v_mul_f32_e64 v8, v52, v36
    v_mul_f32_e64 v9, v52, -v37
    v_fma_f32 v8, -v53, -v37, v8
    v_fma_f32 v9, v53, v36, v9
    ds_write_b64 v5, v[8:9] offset:504
    s_waitcnt vmcnt(12)
    s_waitcnt lgkmcnt(0)
    s_barrier
    v_mfma_f32_32x32x16_bf16 v[160:175], v[124:127], v[104:107], v[160:175]
    ds_read_b128 v[96:99], v145 offset:0
    ds_read_b64_tr_b16 v[112:113], v154 offset:16384
    s_add_u32 s96, s60, 384
    s_add_u32 m0, s62, 0
    s_nop 0
    buffer_load_dwordx4 v136, s[16:19], s96 offen lds
    s_waitcnt lgkmcnt(0)
    v_mfma_f32_32x32x16_bf16 v[176:191], v[128:131], v[104:107], v[176:191]
    ds_read_b64_tr_b16 v[114:115], v154 offset:17152
    ds_read_b64_tr_b16 v[116:117], v154 offset:28672
    s_add_u32 s96, s60, 8576
    s_add_u32 m0, s62, 1024
    s_nop 0
    buffer_load_dwordx4 v137, s[16:19], s96 offen lds
    ds_read_b64 v[8:9], v6 offset:0
    v_mfma_f32_32x32x16_bf16 v[192:207], v[132:135], v[104:107], v[192:207]
    ds_read_b64_tr_b16 v[118:119], v154 offset:29440
    ds_read_b64_tr_b16 v[120:121], v157 offset:16384
    s_add_u32 s96, s60, 16768
    s_add_u32 m0, s62, 2048
    s_nop 0
    buffer_load_dwordx4 v136, s[16:19], s96 offen lds
    ds_read_b64 v[10:11], v6 offset:8
    v_mfma_f32_32x32x16_bf16 v[208:223], v[124:127], v[108:111], v[208:223]
    ds_read_b64_tr_b16 v[122:123], v157 offset:17152
    ds_read_b128 v[100:103], v145 offset:4096
    s_add_u32 s96, s60, 24960
    s_add_u32 m0, s62, 3072
    s_nop 0
    buffer_load_dwordx4 v137, s[16:19], s96 offen lds
    ds_read_b64 v[12:13], v6 offset:16
    v_mfma_f32_32x32x16_bf16 v[224:239], v[128:131], v[108:111], v[224:239]
    s_add_u32 s96, s61, 528384
    s_add_u32 m0, s63, 0
    s_nop 0
    buffer_load_dwordx4 v138, s[64:67], s96 offen lds
    ds_read_b64 v[14:15], v6 offset:24
    ds_read_b64 v[16:17], v6 offset:32
    ds_read_b64 v[18:19], v6 offset:40
    v_mfma_f32_32x32x16_bf16 v[240:255], v[132:135], v[108:111], v[240:255]
    s_add_u32 s96, s61, 528384
    s_add_u32 m0, s63, 1024
    s_nop 0
    buffer_load_dwordx4 v139, s[64:67], s96 offen lds
    ds_read_b64 v[20:21], v6 offset:48
    ds_read_b64 v[22:23], v6 offset:56
    s_waitcnt lgkmcnt(0)
    v_mfma_f32_32x32x16_bf16 v[160:175], v[112:115], v[96:99], v[160:175]
    ds_read_b128 v[104:107], v146 offset:0
    ds_read_b64_tr_b16 v[124:125], v154 offset:19456
    s_add_u32 s96, s61, 528384
    s_add_u32 m0, s63, 2048
    s_nop 0
    buffer_load_dwordx4 v140, s[64:67], s96 offen lds
    v_add_f32 v24, v8, v16
    v_mfma_f32_32x32x16_bf16 v[176:191], v[116:119], v[96:99], v[176:191]
    ds_read_b64_tr_b16 v[126:127], v154 offset:20224
    ds_read_b64_tr_b16 v[128:129], v154 offset:31744
    s_add_u32 s96, s61, 572416
    s_add_u32 m0, s63, 3072
    s_nop 0
    buffer_load_dwordx4 v138, s[64:67], s96 offen lds
    v_add_f32 v25, v9, v17
    v_mfma_f32_32x32x16_bf16 v[192:207], v[120:123], v[96:99], v[192:207]
    ds_read_b64_tr_b16 v[130:131], v154 offset:32512
    ds_read_b64_tr_b16 v[132:133], v157 offset:19456
    s_add_u32 s96, s61, 572416
    s_add_u32 m0, s63, 4096
    s_nop 0
    buffer_load_dwordx4 v139, s[64:67], s96 offen lds
    v_sub_f32 v26, v8, v16
    v_mfma_f32_32x32x16_bf16 v[208:223], v[112:115], v[100:103], v[208:223]
    ds_read_b64_tr_b16 v[134:135], v157 offset:20224
    ds_read_b128 v[108:111], v146 offset:4096
    s_add_u32 s96, s61, 572416
    s_add_u32 m0, s63, 5120
    s_nop 0
    buffer_load_dwordx4 v140, s[64:67], s96 offen lds
    v_sub_f32 v27, v9, v17
    v_mfma_f32_32x32x16_bf16 v[224:239], v[116:119], v[100:103], v[224:239]
    v_add_f32 v8, v10, v18
    v_add_f32 v9, v11, v19
    v_sub_f32 v16, v10, v18
    v_sub_f32 v17, v11, v19
    v_mfma_f32_32x32x16_bf16 v[240:255], v[120:123], v[100:103], v[240:255]
    v_add_f32 v10, v12, v20
    v_add_f32 v11, v13, v21
    v_sub_f32 v18, v12, v20
    v_sub_f32 v19, v13, v21
    s_waitcnt lgkmcnt(5)
    v_mfma_f32_32x32x16_bf16 v[160:175], v[124:127], v[104:107], v[160:175]
    ds_read_b128 v[96:99], v147 offset:0
    ds_read_b64_tr_b16 v[112:113], v154 offset:22528
    v_add_f32 v12, v14, v22
    v_add_f32 v13, v15, v23
    s_waitcnt lgkmcnt(5)
    v_mfma_f32_32x32x16_bf16 v[176:191], v[128:131], v[104:107], v[176:191]
    ds_read_b64_tr_b16 v[114:115], v154 offset:23296
    ds_read_b64_tr_b16 v[116:117], v154 offset:34816
    v_sub_f32 v20, v14, v22
    v_sub_f32 v21, v15, v23
    s_waitcnt lgkmcnt(5)
    v_mfma_f32_32x32x16_bf16 v[192:207], v[132:135], v[104:107], v[192:207]
    ds_read_b64_tr_b16 v[118:119], v154 offset:35584
    ds_read_b64_tr_b16 v[120:121], v157 offset:22528
    v_add_f32 v14, v16, v17
    v_sub_f32 v15, v17, v16
    s_waitcnt lgkmcnt(6)
    v_mfma_f32_32x32x16_bf16 v[208:223], v[124:127], v[108:111], v[208:223]
    ds_read_b64_tr_b16 v[122:123], v157 offset:23296
    ds_read_b128 v[100:103], v147 offset:4096
    v_sub_f32 v22, v21, v20
    v_add_f32 v23, v21, v20
    v_mfma_f32_32x32x16_bf16 v[224:239], v[128:131], v[108:111], v[224:239]
    v_add_f32 v16, v24, v10
    v_add_f32 v17, v25, v11
    v_sub_f32 v20, v24, v10
    v_sub_f32 v21, v25, v11
    v_mfma_f32_32x32x16_bf16 v[240:255], v[132:135], v[108:111], v[240:255]
    v_add_f32 v28, v8, v12
    v_add_f32 v29, v9, v13
    v_sub_f32 v30, v8, v12
    v_sub_f32 v31, v9, v13
    s_waitcnt lgkmcnt(5)
    v_mfma_f32_32x32x16_bf16 v[160:175], v[112:115], v[96:99], v[160:175]
    ds_read_b128 v[104:107], v148 offset:0
    ds_read_b64_tr_b16 v[124:125], v154 offset:25600
    v_add_f32 v8, v26, v19
    v_sub_f32 v9, v27, v18
    s_waitcnt lgkmcnt(5)
    v_mfma_f32_32x32x16_bf16 v[176:191], v[116:119], v[96:99], v[176:191]
    ds_read_b64_tr_b16 v[126:127], v154 offset:26368
    ds_read_b64_tr_b16 v[128:129], v154 offset:37888
    v_sub_f32 v10, v26, v19
    v_add_f32 v11, v27, v18
    s_waitcnt lgkmcnt(5)
    v_mfma_f32_32x32x16_bf16 v[192:207], v[120:123], v[96:99], v[192:207]
    ds_read_b64_tr_b16 v[130:131], v154 offset:38656
    ds_read_b64_tr_b16 v[132:133], v157 offset:25600
    v_add_f32 v12, v14, v22
    v_sub_f32 v13, v15, v23
    s_waitcnt lgkmcnt(6)
    v_mfma_f32_32x32x16_bf16 v[208:223], v[112:115], v[100:103], v[208:223]
    ds_read_b64_tr_b16 v[134:135], v157 offset:26368
    ds_read_b128 v[108:111], v148 offset:4096
    v_sub_f32 v18, v14, v22
    v_add_f32 v19, v15, v23
    v_mfma_f32_32x32x16_bf16 v[224:239], v[116:119], v[100:103], v[224:239]
    v_add_f32 v14, v16, v28
    v_add_f32 v15, v17, v29
    v_sub_f32 v22, v16, v28
    v_sub_f32 v23, v17, v29
    v_mfma_f32_32x32x16_bf16 v[240:255], v[120:123], v[100:103], v[240:255]
    v_add_f32 v24, v20, v31
    v_sub_f32 v25, v21, v30
    v_sub_f32 v26, v20, v31
    v_add_f32 v27, v21, v30
    v_fma_f32 v32, v12, s30, v8
    v_fma_f32 v33, v13, s30, v9
    v_fma_f32 v34, -v12, s30, v8
    v_fma_f32 v35, -v13, s30, v9
    v_fma_f32 v36, v19, s30, v10
    v_fma_f32 v37, -v18, s30, v11
    v_fma_f32 v38, -v19, s30, v10
    v_fma_f32 v39, v18, s30, v11
    v_lshrrev_b32 v4, 3, v1
    v_and_b32 v5, 7, v1
    v_lshl_add_u32 v4, v5, 3, v4
    v_mul_u32_u24 v5, 520, v2
    v_add_u32 v4, v4, v5
    v_lshlrev_b32 v4, 3, v4
    v_add_u32 v4, 122880, v4
    ds_write_b64 v4, v[14:15] offset:18432
    ds_write_b64 v4, v[32:33] offset:18944
    ds_write_b64 v4, v[24:25] offset:19456
    ds_write_b64 v4, v[36:37] offset:19968
    ds_write_b64 v4, v[22:23] offset:20480
    ds_write_b64 v4, v[34:35] offset:20992
    ds_write_b64 v4, v[26:27] offset:21504
    ds_write_b64 v4, v[38:39] offset:22016
    s_mov_b64 exec, 1
    ds_write_b64 v4, v[14:15] offset:22528
    s_mov_b64 exec, -1
    s_waitcnt lgkmcnt(0)
    s_waitcnt vmcnt(12)
    s_waitcnt lgkmcnt(0)
    s_barrier
    v_mfma_f32_32x32x16_bf16 v[160:175], v[124:127], v[104:107], v[160:175]
    ds_read_b128 v[96:99], v149 offset:0
    ds_read_b64_tr_b16 v[112:113], v155 offset:16384
    s_add_u32 s96, s60, 512
    s_add_u32 m0, s62, 40960
    s_nop 0
    buffer_load_dwordx4 v136, s[16:19], s96 offen lds
    v_and_b32 v4, 3, v0
    v_mfma_f32_32x32x16_bf16 v[176:191], v[128:131], v[104:107], v[176:191]
    ds_read_b64_tr_b16 v[114:115], v155 offset:17152
    ds_read_b64_tr_b16 v[116:117], v155 offset:28672
    s_add_u32 s96, s60, 8704
    s_add_u32 m0, s62, 41984
    s_nop 0
    buffer_load_dwordx4 v137, s[16:19], s96 offen lds
    v_lshrrev_b32 v5, 2, v0
    v_mfma_f32_32x32x16_bf16 v[192:207], v[132:135], v[104:107], v[192:207]
    ds_read_b64_tr_b16 v[118:119], v155 offset:29440
    ds_read_b64_tr_b16 v[120:121], v158 offset:16384
    s_add_u32 s96, s60, 16896
    s_add_u32 m0, s62, 43008
    s_nop 0
    buffer_load_dwordx4 v136, s[16:19], s96 offen lds
    v_mul_u32_u24 v6, 520, v4
    v_mfma_f32_32x32x16_bf16 v[208:223], v[124:127], v[108:111], v[208:223]
    ds_read_b64_tr_b16 v[122:123], v158 offset:17152
    ds_read_b128 v[100:103], v149 offset:4096
    s_add_u32 s96, s60, 25088
    s_add_u32 m0, s62, 44032
    s_nop 0
    buffer_load_dwordx4 v137, s[16:19], s96 offen lds
    v_sub_u32 v7, v6, v5
    v_mfma_f32_32x32x16_bf16 v[224:239], v[128:131], v[108:111], v[224:239]
    s_add_u32 s96, s61, 704512
    s_add_u32 m0, s63, 40960
    s_nop 0
    buffer_load_dwordx4 v138, s[64:67], s96 offen lds
    v_add_u32 v6, v6, v5
    v_lshlrev_b32 v6, 3, v6
    v_add_u32 v7, 256, v7
    v_mfma_f32_32x32x16_bf16 v[240:255], v[132:135], v[108:111], v[240:255]
    s_add_u32 s96, s61, 704512
    s_add_u32 m0, s63, 41984
    s_nop 0
    buffer_load_dwordx4 v139, s[64:67], s96 offen lds
    v_lshlrev_b32 v7, 3, v7
    v_add_u32 v6, 122880, v6
    v_add_u32 v7, 122880, v7
    s_waitcnt lgkmcnt(5)
    v_mfma_f32_32x32x16_bf16 v[160:175], v[112:115], v[96:99], v[160:175]
    ds_read_b128 v[104:107], v150 offset:0
    ds_read_b64_tr_b16 v[124:125], v155 offset:19456
    s_add_u32 s96, s61, 704512
    s_add_u32 m0, s63, 43008
    s_nop 0
    buffer_load_dwordx4 v140, s[64:67], s96 offen lds
    v_mul_u32_u24 v8, 16640, v5
    s_waitcnt lgkmcnt(5)
    v_mfma_f32_32x32x16_bf16 v[176:191], v[116:119], v[96:99], v[176:191]
    ds_read_b64_tr_b16 v[126:127], v155 offset:20224
    ds_read_b64_tr_b16 v[128:129], v155 offset:31744
    s_add_u32 s96, s61, 748544
    s_add_u32 m0, s63, 44032
    s_nop 0
    buffer_load_dwordx4 v138, s[64:67], s96 offen lds
    v_lshl_add_u32 v8, v4, 4, v8
    s_waitcnt lgkmcnt(5)
    v_mfma_f32_32x32x16_bf16 v[192:207], v[120:123], v[96:99], v[192:207]
    ds_read_b64_tr_b16 v[130:131], v155 offset:32512
    ds_read_b64_tr_b16 v[132:133], v158 offset:19456
    s_add_u32 s96, s61, 748544
    s_add_u32 m0, s63, 45056
    s_nop 0
    buffer_load_dwordx4 v139, s[64:67], s96 offen lds
    s_lshl_b32 s29, s2, 6
    s_waitcnt lgkmcnt(6)
    v_mfma_f32_32x32x16_bf16 v[208:223], v[112:115], v[100:103], v[208:223]
    ds_read_b64_tr_b16 v[134:135], v158 offset:20224
    ds_read_b128 v[108:111], v150 offset:4096
    s_add_u32 s96, s61, 748544
    s_add_u32 m0, s63, 46080
    s_nop 0
    buffer_load_dwordx4 v140, s[64:67], s96 offen lds
    ds_read_b64 v[10:11], v6 offset:18432
    v_mfma_f32_32x32x16_bf16 v[224:239], v[116:119], v[100:103], v[224:239]
    ds_read_b64 v[18:19], v7 offset:20480
    ds_read_b64 v[12:13], v6 offset:18944
    ds_read_b64 v[20:21], v7 offset:19968
    ds_read_b64 v[14:15], v6 offset:19456
    v_mfma_f32_32x32x16_bf16 v[240:255], v[120:123], v[100:103], v[240:255]
    ds_read_b64 v[22:23], v7 offset:19456
    ds_read_b64 v[16:17], v6 offset:19968
    ds_read_b64 v[24:25], v7 offset:18944
    s_waitcnt lgkmcnt(6)
    v_mfma_f32_32x32x16_bf16 v[160:175], v[124:127], v[104:107], v[160:175]
    ds_read_b128 v[96:99], v151 offset:0
    ds_read_b64_tr_b16 v[112:113], v155 offset:22528
    v_add_f32 v28, v10, v18
    v_sub_f32 v29, v11, v19
    v_mfma_f32_32x32x16_bf16 v[176:191], v[128:131], v[104:107], v[176:191]
    ds_read_b64_tr_b16 v[114:115], v155 offset:23296
    ds_read_b64_tr_b16 v[116:117], v155 offset:34816
    v_add_f32 v30, v11, v19
    v_sub_f32 v31, v18, v10
    v_mfma_f32_32x32x16_bf16 v[192:207], v[132:135], v[104:107], v[192:207]
    ds_read_b64_tr_b16 v[118:119], v155 offset:35584
    ds_read_b64_tr_b16 v[120:121], v158 offset:22528
    s_add_u32 s31, s29, 0x0
    buffer_store_dwordx4 v[28:31], v8, s[24:27], s31 offen
    v_mfma_f32_32x32x16_bf16 v[208:223], v[124:127], v[108:111], v[208:223]
    ds_read_b64_tr_b16 v[122:123], v158 offset:23296
    ds_read_b128 v[100:103], v151 offset:4096
    s_waitcnt lgkmcnt(4)
    v_add_f32 v32, v12, v20
    v_mfma_f32_32x32x16_bf16 v[224:239], v[128:131], v[108:111], v[224:239]
    v_sub_f32 v33, v13, v21
    v_add_f32 v34, v13, v21
    v_sub_f32 v35, v20, v12
    s_add_u32 s31, s29, 0x104000
    v_mfma_f32_32x32x16_bf16 v[240:255], v[132:135], v[108:111], v[240:255]
    buffer_store_dwordx4 v[32:35], v8, s[24:27], s31 offen
    s_waitcnt lgkmcnt(2)
    v_add_f32 v36, v14, v22
    v_sub_f32 v37, v15, v23
    v_mfma_f32_32x32x16_bf16 v[160:175], v[112:115], v[96:99], v[160:175]
    ds_read_b128 v[104:107], v152 offset:0
    ds_read_b64_tr_b16 v[124:125], v155 offset:25600
    v_add_f32 v38, v15, v23
    v_sub_f32 v39, v22, v14
    v_mfma_f32_32x32x16_bf16 v[176:191], v[116:119], v[96:99], v[176:191]
    ds_read_b64_tr_b16 v[126:127], v155 offset:26368
    ds_read_b64_tr_b16 v[128:129], v155 offset:37888
    s_add_u32 s31, s29, 0x208000
    buffer_store_dwordx4 v[36:39], v8, s[24:27], s31 offen
    s_waitcnt lgkmcnt(5)
    v_mfma_f32_32x32x16_bf16 v[192:207], v[120:123], v[96:99], v[192:207]
    ds_read_b64_tr_b16 v[130:131], v155 offset:38656
    ds_read_b64_tr_b16 v[132:133], v158 offset:25600
    s_waitcnt lgkmcnt(0)
    v_add_f32 v40, v16, v24
    v_mfma_f32_32x32x16_bf16 v[208:223], v[112:115], v[100:103], v[208:223]
    ds_read_b64_tr_b16 v[134:135], v158 offset:26368
    ds_read_b128 v[108:111], v152 offset:4096
    v_sub_f32 v41, v17, v25
    v_add_f32 v42, v17, v25
    v_mfma_f32_32x32x16_bf16 v[224:239], v[116:119], v[100:103], v[224:239]
    v_sub_f32 v43, v24, v16
    s_add_u32 s31, s29, 0x30c000
    buffer_store_dwordx4 v[40:43], v8, s[24:27], s31 offen
    v_cmp_gt_u32 vcc, 4, v0
    v_mfma_f32_32x32x16_bf16 v[240:255], v[120:123], v[100:103], v[240:255]
    s_waitcnt lgkmcnt(0)
    s_and_saveexec_b64 s[48:49], vcc
    s_cbranch_execz K1O256_2
    ds_read_b64 v[10:11], v6 offset:20480
    s_waitcnt lgkmcnt(0)
    v_add_f32 v44, v10, v10
    v_mov_b32 v45, 0
    v_add_f32 v46, v11, v11
    v_mov_b32 v47, 0
    s_add_u32 s31, s29, 0x410000
    buffer_store_dwordx4 v[44:47], v8, s[24:27], s31 offen
K1O256_2:
    s_mov_b64 exec, -1
    s_waitcnt vmcnt(14)
    s_waitcnt lgkmcnt(0)
    s_barrier
    v_mfma_f32_32x32x16_bf16 v[160:175], v[124:127], v[104:107], v[160:175]
    ds_read_b128 v[96:99], v141 offset:0
    ds_read_b64_tr_b16 v[112:113], v153 offset:16384
    s_add_u32 s96, s60, 640
    s_add_u32 m0, s62, 81920
    s_nop 0
    buffer_load_dwordx4 v136, s[16:19], s96 offen lds
    v_mfma_f32_32x32x16_bf16 v[176:191], v[128:131], v[104:107], v[176:191]
    ds_read_b64_tr_b16 v[114:115], v153 offset:17152
    ds_read_b64_tr_b16 v[116:117], v153 offset:28672
    s_add_u32 s96, s60, 8832
    s_add_u32 m0, s62, 82944
    s_nop 0
    buffer_load_dwordx4 v137, s[16:19], s96 offen lds
    v_mfma_f32_32x32x16_bf16 v[192:207], v[132:135], v[104:107], v[192:207]
    ds_read_b64_tr_b16 v[118:119], v153 offset:29440
    ds_read_b64_tr_b16 v[120:121], v156 offset:16384
    s_add_u32 s96, s60, 17024
    s_add_u32 m0, s62, 83968
    s_nop 0
    buffer_load_dwordx4 v136, s[16:19], s96 offen lds
    v_mfma_f32_32x32x16_bf16 v[208:223], v[124:127], v[108:111], v[208:223]
    ds_read_b64_tr_b16 v[122:123], v156 offset:17152
    ds_read_b128 v[100:103], v141 offset:4096
    s_add_u32 s96, s60, 25216
    s_add_u32 m0, s62, 84992
    s_nop 0
    buffer_load_dwordx4 v137, s[16:19], s96 offen lds
    v_mfma_f32_32x32x16_bf16 v[224:239], v[128:131], v[108:111], v[224:239]
    s_add_u32 s96, s61, 880640
    s_add_u32 m0, s63, 81920
    s_nop 0
    buffer_load_dwordx4 v138, s[64:67], s96 offen lds
    v_mfma_f32_32x32x16_bf16 v[240:255], v[132:135], v[108:111], v[240:255]
    s_add_u32 s96, s61, 880640
    s_add_u32 m0, s63, 82944
    s_nop 0
    buffer_load_dwordx4 v139, s[64:67], s96 offen lds
    s_waitcnt lgkmcnt(5)
    v_mfma_f32_32x32x16_bf16 v[160:175], v[112:115], v[96:99], v[160:175]
    ds_read_b128 v[104:107], v142 offset:0
    ds_read_b64_tr_b16 v[124:125], v153 offset:19456
    s_add_u32 s96, s61, 880640
    s_add_u32 m0, s63, 83968
    s_nop 0
    buffer_load_dwordx4 v140, s[64:67], s96 offen lds
    s_waitcnt lgkmcnt(5)
    v_mfma_f32_32x32x16_bf16 v[176:191], v[116:119], v[96:99], v[176:191]
    ds_read_b64_tr_b16 v[126:127], v153 offset:20224
    ds_read_b64_tr_b16 v[128:129], v153 offset:31744
    s_add_u32 s96, s61, 924672
    s_add_u32 m0, s63, 84992
    s_nop 0
    buffer_load_dwordx4 v138, s[64:67], s96 offen lds
    s_waitcnt lgkmcnt(5)
    v_mfma_f32_32x32x16_bf16 v[192:207], v[120:123], v[96:99], v[192:207]
    ds_read_b64_tr_b16 v[130:131], v153 offset:32512
    ds_read_b64_tr_b16 v[132:133], v156 offset:19456
    s_add_u32 s96, s61, 924672
    s_add_u32 m0, s63, 86016
    s_nop 0
    buffer_load_dwordx4 v139, s[64:67], s96 offen lds
    s_waitcnt lgkmcnt(6)
    v_mfma_f32_32x32x16_bf16 v[208:223], v[112:115], v[100:103], v[208:223]
    ds_read_b64_tr_b16 v[134:135], v156 offset:20224
    ds_read_b128 v[108:111], v142 offset:4096
    s_add_u32 s96, s61, 924672
    s_add_u32 m0, s63, 87040
    s_nop 0
    buffer_load_dwordx4 v140, s[64:67], s96 offen lds
    v_mfma_f32_32x32x16_bf16 v[224:239], v[116:119], v[100:103], v[224:239]
    v_mfma_f32_32x32x16_bf16 v[240:255], v[120:123], v[100:103], v[240:255]
    s_waitcnt lgkmcnt(5)
    v_mfma_f32_32x32x16_bf16 v[160:175], v[124:127], v[104:107], v[160:175]
    ds_read_b128 v[96:99], v143 offset:0
    ds_read_b64_tr_b16 v[112:113], v153 offset:22528
    s_waitcnt lgkmcnt(5)
    v_mfma_f32_32x32x16_bf16 v[176:191], v[128:131], v[104:107], v[176:191]
    ds_read_b64_tr_b16 v[114:115], v153 offset:23296
    ds_read_b64_tr_b16 v[116:117], v153 offset:34816
    s_waitcnt lgkmcnt(5)
    v_mfma_f32_32x32x16_bf16 v[192:207], v[132:135], v[104:107], v[192:207]
    ds_read_b64_tr_b16 v[118:119], v153 offset:35584
    ds_read_b64_tr_b16 v[120:121], v156 offset:22528
    s_waitcnt lgkmcnt(6)
    v_mfma_f32_32x32x16_bf16 v[208:223], v[124:127], v[108:111], v[208:223]
    ds_read_b64_tr_b16 v[122:123], v156 offset:23296
    ds_read_b128 v[100:103], v143 offset:4096
    v_mfma_f32_32x32x16_bf16 v[224:239], v[128:131], v[108:111], v[224:239]
    v_mfma_f32_32x32x16_bf16 v[240:255], v[132:135], v[108:111], v[240:255]
    s_waitcnt lgkmcnt(5)
    v_mfma_f32_32x32x16_bf16 v[160:175], v[112:115], v[96:99], v[160:175]
    ds_read_b128 v[104:107], v144 offset:0
    ds_read_b64_tr_b16 v[124:125], v153 offset:25600
    s_waitcnt lgkmcnt(5)
    v_mfma_f32_32x32x16_bf16 v[176:191], v[116:119], v[96:99], v[176:191]
    ds_read_b64_tr_b16 v[126:127], v153 offset:26368
    ds_read_b64_tr_b16 v[128:129], v153 offset:37888
    s_waitcnt lgkmcnt(5)
    v_mfma_f32_32x32x16_bf16 v[192:207], v[120:123], v[96:99], v[192:207]
    ds_read_b64_tr_b16 v[130:131], v153 offset:38656
    ds_read_b64_tr_b16 v[132:133], v156 offset:25600
    s_waitcnt lgkmcnt(6)
    v_mfma_f32_32x32x16_bf16 v[208:223], v[112:115], v[100:103], v[208:223]
    ds_read_b64_tr_b16 v[134:135], v156 offset:26368
    ds_read_b128 v[108:111], v144 offset:4096
    v_mfma_f32_32x32x16_bf16 v[224:239], v[116:119], v[100:103], v[224:239]
    v_mfma_f32_32x32x16_bf16 v[240:255], v[120:123], v[100:103], v[240:255]
    s_waitcnt vmcnt(14)
    s_waitcnt lgkmcnt(0)
    s_barrier
    v_mfma_f32_32x32x16_bf16 v[160:175], v[124:127], v[104:107], v[160:175]
    ds_read_b128 v[96:99], v145 offset:0
    ds_read_b64_tr_b16 v[112:113], v154 offset:16384
    s_add_u32 s96, s60, 768
    s_add_u32 m0, s62, 0
    s_nop 0
    buffer_load_dwordx4 v136, s[16:19], s96 offen lds
    v_mfma_f32_32x32x16_bf16 v[176:191], v[128:131], v[104:107], v[176:191]
    ds_read_b64_tr_b16 v[114:115], v154 offset:17152
    ds_read_b64_tr_b16 v[116:117], v154 offset:28672
    s_add_u32 s96, s60, 8960
    s_add_u32 m0, s62, 1024
    s_nop 0
    buffer_load_dwordx4 v137, s[16:19], s96 offen lds
    v_mfma_f32_32x32x16_bf16 v[192:207], v[132:135], v[104:107], v[192:207]
    ds_read_b64_tr_b16 v[118:119], v154 offset:29440
    ds_read_b64_tr_b16 v[120:121], v157 offset:16384
    s_add_u32 s96, s60, 17152
    s_add_u32 m0, s62, 2048
    s_nop 0
    buffer_load_dwordx4 v136, s[16:19], s96 offen lds
    v_mfma_f32_32x32x16_bf16 v[208:223], v[124:127], v[108:111], v[208:223]
    ds_read_b64_tr_b16 v[122:123], v157 offset:17152
    ds_read_b128 v[100:103], v145 offset:4096
    s_add_u32 s96, s60, 25344
    s_add_u32 m0, s62, 3072
    s_nop 0
    buffer_load_dwordx4 v137, s[16:19], s96 offen lds
    v_mfma_f32_32x32x16_bf16 v[224:239], v[128:131], v[108:111], v[224:239]
    s_add_u32 s96, s61, 1056768
    s_add_u32 m0, s63, 0
    s_nop 0
    buffer_load_dwordx4 v138, s[64:67], s96 offen lds
    v_mfma_f32_32x32x16_bf16 v[240:255], v[132:135], v[108:111], v[240:255]
    s_add_u32 s96, s61, 1056768
    s_add_u32 m0, s63, 1024
    s_nop 0
    buffer_load_dwordx4 v139, s[64:67], s96 offen lds
    s_waitcnt lgkmcnt(5)
    v_mfma_f32_32x32x16_bf16 v[160:175], v[112:115], v[96:99], v[160:175]
    ds_read_b128 v[104:107], v146 offset:0
    ds_read_b64_tr_b16 v[124:125], v154 offset:19456
    s_add_u32 s96, s61, 1056768
    s_add_u32 m0, s63, 2048
    s_nop 0
    buffer_load_dwordx4 v140, s[64:67], s96 offen lds
    s_waitcnt lgkmcnt(5)
    v_mfma_f32_32x32x16_bf16 v[176:191], v[116:119], v[96:99], v[176:191]
    ds_read_b64_tr_b16 v[126:127], v154 offset:20224
    ds_read_b64_tr_b16 v[128:129], v154 offset:31744
    s_add_u32 s96, s61, 1100800
    s_add_u32 m0, s63, 3072
    s_nop 0
    buffer_load_dwordx4 v138, s[64:67], s96 offen lds
    s_waitcnt lgkmcnt(5)
    v_mfma_f32_32x32x16_bf16 v[192:207], v[120:123], v[96:99], v[192:207]
    ds_read_b64_tr_b16 v[130:131], v154 offset:32512
    ds_read_b64_tr_b16 v[132:133], v157 offset:19456
    s_add_u32 s96, s61, 1100800
    s_add_u32 m0, s63, 4096
    s_nop 0
    buffer_load_dwordx4 v139, s[64:67], s96 offen lds
    s_waitcnt lgkmcnt(6)
    v_mfma_f32_32x32x16_bf16 v[208:223], v[112:115], v[100:103], v[208:223]
    ds_read_b64_tr_b16 v[134:135], v157 offset:20224
    ds_read_b128 v[108:111], v146 offset:4096
    s_add_u32 s96, s61, 1100800
    s_add_u32 m0, s63, 5120
    s_nop 0
    buffer_load_dwordx4 v140, s[64:67], s96 offen lds
    v_mfma_f32_32x32x16_bf16 v[224:239], v[116:119], v[100:103], v[224:239]
    v_mfma_f32_32x32x16_bf16 v[240:255], v[120:123], v[100:103], v[240:255]
    s_waitcnt lgkmcnt(5)
    v_mfma_f32_32x32x16_bf16 v[160:175], v[124:127], v[104:107], v[160:175]
    ds_read_b128 v[96:99], v147 offset:0
    ds_read_b64_tr_b16 v[112:113], v154 offset:22528
    s_waitcnt lgkmcnt(5)
    v_mfma_f32_32x32x16_bf16 v[176:191], v[128:131], v[104:107], v[176:191]
    ds_read_b64_tr_b16 v[114:115], v154 offset:23296
    ds_read_b64_tr_b16 v[116:117], v154 offset:34816
    s_waitcnt lgkmcnt(5)
    v_mfma_f32_32x32x16_bf16 v[192:207], v[132:135], v[104:107], v[192:207]
    ds_read_b64_tr_b16 v[118:119], v154 offset:35584
    ds_read_b64_tr_b16 v[120:121], v157 offset:22528
    s_waitcnt lgkmcnt(6)
    v_mfma_f32_32x32x16_bf16 v[208:223], v[124:127], v[108:111], v[208:223]
    ds_read_b64_tr_b16 v[122:123], v157 offset:23296
    ds_read_b128 v[100:103], v147 offset:4096
    v_mfma_f32_32x32x16_bf16 v[224:239], v[128:131], v[108:111], v[224:239]
    v_mfma_f32_32x32x16_bf16 v[240:255], v[132:135], v[108:111], v[240:255]
    s_waitcnt lgkmcnt(5)
    v_mfma_f32_32x32x16_bf16 v[160:175], v[112:115], v[96:99], v[160:175]
    ds_read_b128 v[104:107], v148 offset:0
    ds_read_b64_tr_b16 v[124:125], v154 offset:25600
    s_waitcnt lgkmcnt(5)
    v_mfma_f32_32x32x16_bf16 v[176:191], v[116:119], v[96:99], v[176:191]
    ds_read_b64_tr_b16 v[126:127], v154 offset:26368
    ds_read_b64_tr_b16 v[128:129], v154 offset:37888
    s_waitcnt lgkmcnt(5)
    v_mfma_f32_32x32x16_bf16 v[192:207], v[120:123], v[96:99], v[192:207]
    ds_read_b64_tr_b16 v[130:131], v154 offset:38656
    ds_read_b64_tr_b16 v[132:133], v157 offset:25600
    s_waitcnt lgkmcnt(6)
    v_mfma_f32_32x32x16_bf16 v[208:223], v[112:115], v[100:103], v[208:223]
    ds_read_b64_tr_b16 v[134:135], v157 offset:26368
    ds_read_b128 v[108:111], v148 offset:4096
    v_mfma_f32_32x32x16_bf16 v[224:239], v[116:119], v[100:103], v[224:239]
    v_mfma_f32_32x32x16_bf16 v[240:255], v[120:123], v[100:103], v[240:255]
    s_waitcnt vmcnt(10)
    s_waitcnt lgkmcnt(0)
    s_barrier
    v_mfma_f32_32x32x16_bf16 v[160:175], v[124:127], v[104:107], v[160:175]
    ds_read_b128 v[96:99], v149 offset:0
    ds_read_b64_tr_b16 v[112:113], v155 offset:16384
    s_add_u32 s96, s60, 896
    s_add_u32 m0, s62, 40960
    s_nop 0
    buffer_load_dwordx4 v136, s[16:19], s96 offen lds
    v_mfma_f32_32x32x16_bf16 v[176:191], v[128:131], v[104:107], v[176:191]
    ds_read_b64_tr_b16 v[114:115], v155 offset:17152
    ds_read_b64_tr_b16 v[116:117], v155 offset:28672
    s_add_u32 s96, s60, 9088
    s_add_u32 m0, s62, 41984
    s_nop 0
    buffer_load_dwordx4 v137, s[16:19], s96 offen lds
    v_mfma_f32_32x32x16_bf16 v[192:207], v[132:135], v[104:107], v[192:207]
    ds_read_b64_tr_b16 v[118:119], v155 offset:29440
    ds_read_b64_tr_b16 v[120:121], v158 offset:16384
    s_add_u32 s96, s60, 17280
    s_add_u32 m0, s62, 43008
    s_nop 0
    buffer_load_dwordx4 v136, s[16:19], s96 offen lds
    v_mfma_f32_32x32x16_bf16 v[208:223], v[124:127], v[108:111], v[208:223]
    ds_read_b64_tr_b16 v[122:123], v158 offset:17152
    ds_read_b128 v[100:103], v149 offset:4096
    s_add_u32 s96, s60, 25472
    s_add_u32 m0, s62, 44032
    s_nop 0
    buffer_load_dwordx4 v137, s[16:19], s96 offen lds
    v_mfma_f32_32x32x16_bf16 v[224:239], v[128:131], v[108:111], v[224:239]
    s_add_u32 s96, s61, 1232896
    s_add_u32 m0, s63, 40960
    s_nop 0
    buffer_load_dwordx4 v138, s[64:67], s96 offen lds
    v_mfma_f32_32x32x16_bf16 v[240:255], v[132:135], v[108:111], v[240:255]
    s_add_u32 s96, s61, 1232896
    s_add_u32 m0, s63, 41984
    s_nop 0
    buffer_load_dwordx4 v139, s[64:67], s96 offen lds
    s_waitcnt lgkmcnt(5)
    v_mfma_f32_32x32x16_bf16 v[160:175], v[112:115], v[96:99], v[160:175]
    ds_read_b128 v[104:107], v150 offset:0
    ds_read_b64_tr_b16 v[124:125], v155 offset:19456
    s_add_u32 s96, s61, 1232896
    s_add_u32 m0, s63, 43008
    s_nop 0
    buffer_load_dwordx4 v140, s[64:67], s96 offen lds
    s_waitcnt lgkmcnt(5)
    v_mfma_f32_32x32x16_bf16 v[176:191], v[116:119], v[96:99], v[176:191]
    ds_read_b64_tr_b16 v[126:127], v155 offset:20224
    ds_read_b64_tr_b16 v[128:129], v155 offset:31744
    s_add_u32 s96, s61, 1276928
    s_add_u32 m0, s63, 44032
    s_nop 0
    buffer_load_dwordx4 v138, s[64:67], s96 offen lds
    s_waitcnt lgkmcnt(5)
    v_mfma_f32_32x32x16_bf16 v[192:207], v[120:123], v[96:99], v[192:207]
    ds_read_b64_tr_b16 v[130:131], v155 offset:32512
    ds_read_b64_tr_b16 v[132:133], v158 offset:19456
    s_add_u32 s96, s61, 1276928
    s_add_u32 m0, s63, 45056
    s_nop 0
    buffer_load_dwordx4 v139, s[64:67], s96 offen lds
    s_waitcnt lgkmcnt(6)
    v_mfma_f32_32x32x16_bf16 v[208:223], v[112:115], v[100:103], v[208:223]
    ds_read_b64_tr_b16 v[134:135], v158 offset:20224
    ds_read_b128 v[108:111], v150 offset:4096
    s_add_u32 s96, s61, 1276928
    s_add_u32 m0, s63, 46080
    s_nop 0
    buffer_load_dwordx4 v140, s[64:67], s96 offen lds
    v_mfma_f32_32x32x16_bf16 v[224:239], v[116:119], v[100:103], v[224:239]
    v_mfma_f32_32x32x16_bf16 v[240:255], v[120:123], v[100:103], v[240:255]
    s_waitcnt lgkmcnt(5)
    v_mfma_f32_32x32x16_bf16 v[160:175], v[124:127], v[104:107], v[160:175]
    ds_read_b128 v[96:99], v151 offset:0
    ds_read_b64_tr_b16 v[112:113], v155 offset:22528
    s_waitcnt lgkmcnt(5)
    v_mfma_f32_32x32x16_bf16 v[176:191], v[128:131], v[104:107], v[176:191]
    ds_read_b64_tr_b16 v[114:115], v155 offset:23296
    ds_read_b64_tr_b16 v[116:117], v155 offset:34816
    s_waitcnt lgkmcnt(5)
    v_mfma_f32_32x32x16_bf16 v[192:207], v[132:135], v[104:107], v[192:207]
    ds_read_b64_tr_b16 v[118:119], v155 offset:35584
    ds_read_b64_tr_b16 v[120:121], v158 offset:22528
    s_waitcnt lgkmcnt(6)
    v_mfma_f32_32x32x16_bf16 v[208:223], v[124:127], v[108:111], v[208:223]
    ds_read_b64_tr_b16 v[122:123], v158 offset:23296
    ds_read_b128 v[100:103], v151 offset:4096
    v_mfma_f32_32x32x16_bf16 v[224:239], v[128:131], v[108:111], v[224:239]
    v_mfma_f32_32x32x16_bf16 v[240:255], v[132:135], v[108:111], v[240:255]
    s_waitcnt lgkmcnt(5)
    v_mfma_f32_32x32x16_bf16 v[160:175], v[112:115], v[96:99], v[160:175]
    ds_read_b128 v[104:107], v152 offset:0
    ds_read_b64_tr_b16 v[124:125], v155 offset:25600
    s_waitcnt lgkmcnt(5)
    v_mfma_f32_32x32x16_bf16 v[176:191], v[116:119], v[96:99], v[176:191]
    ds_read_b64_tr_b16 v[126:127], v155 offset:26368
    ds_read_b64_tr_b16 v[128:129], v155 offset:37888
    s_waitcnt lgkmcnt(5)
    v_mfma_f32_32x32x16_bf16 v[192:207], v[120:123], v[96:99], v[192:207]
    ds_read_b64_tr_b16 v[130:131], v155 offset:38656
    ds_read_b64_tr_b16 v[132:133], v158 offset:25600
    s_waitcnt lgkmcnt(6)
    v_mfma_f32_32x32x16_bf16 v[208:223], v[112:115], v[100:103], v[208:223]
    ds_read_b64_tr_b16 v[134:135], v158 offset:26368
    ds_read_b128 v[108:111], v152 offset:4096
    v_mfma_f32_32x32x16_bf16 v[224:239], v[116:119], v[100:103], v[224:239]
    v_mfma_f32_32x32x16_bf16 v[240:255], v[120:123], v[100:103], v[240:255]
    s_waitcnt vmcnt(10)
    s_waitcnt lgkmcnt(0)
    s_barrier
    v_mfma_f32_32x32x16_bf16 v[160:175], v[124:127], v[104:107], v[160:175]
    ds_read_b128 v[96:99], v141 offset:0
    ds_read_b64_tr_b16 v[112:113], v153 offset:16384
    v_mfma_f32_32x32x16_bf16 v[176:191], v[128:131], v[104:107], v[176:191]
    ds_read_b64_tr_b16 v[114:115], v153 offset:17152
    ds_read_b64_tr_b16 v[116:117], v153 offset:28672
    v_mfma_f32_32x32x16_bf16 v[192:207], v[132:135], v[104:107], v[192:207]
    ds_read_b64_tr_b16 v[118:119], v153 offset:29440
    ds_read_b64_tr_b16 v[120:121], v156 offset:16384
    v_mfma_f32_32x32x16_bf16 v[208:223], v[124:127], v[108:111], v[208:223]
    ds_read_b64_tr_b16 v[122:123], v156 offset:17152
    ds_read_b128 v[100:103], v141 offset:4096
    v_mfma_f32_32x32x16_bf16 v[224:239], v[128:131], v[108:111], v[224:239]
    v_mfma_f32_32x32x16_bf16 v[240:255], v[132:135], v[108:111], v[240:255]
    s_waitcnt lgkmcnt(5)
    v_mfma_f32_32x32x16_bf16 v[160:175], v[112:115], v[96:99], v[160:175]
    ds_read_b128 v[104:107], v142 offset:0
    ds_read_b64_tr_b16 v[124:125], v153 offset:19456
    s_waitcnt lgkmcnt(5)
    v_mfma_f32_32x32x16_bf16 v[176:191], v[116:119], v[96:99], v[176:191]
    ds_read_b64_tr_b16 v[126:127], v153 offset:20224
    ds_read_b64_tr_b16 v[128:129], v153 offset:31744
    s_waitcnt lgkmcnt(5)
    v_mfma_f32_32x32x16_bf16 v[192:207], v[120:123], v[96:99], v[192:207]
    ds_read_b64_tr_b16 v[130:131], v153 offset:32512
    ds_read_b64_tr_b16 v[132:133], v156 offset:19456
    s_waitcnt lgkmcnt(6)
    v_mfma_f32_32x32x16_bf16 v[208:223], v[112:115], v[100:103], v[208:223]
    ds_read_b64_tr_b16 v[134:135], v156 offset:20224
    ds_read_b128 v[108:111], v142 offset:4096
    v_mfma_f32_32x32x16_bf16 v[224:239], v[116:119], v[100:103], v[224:239]
    v_mfma_f32_32x32x16_bf16 v[240:255], v[120:123], v[100:103], v[240:255]
    s_waitcnt lgkmcnt(5)
    v_mfma_f32_32x32x16_bf16 v[160:175], v[124:127], v[104:107], v[160:175]
    ds_read_b128 v[96:99], v143 offset:0
    ds_read_b64_tr_b16 v[112:113], v153 offset:22528
    s_waitcnt lgkmcnt(5)
    v_mfma_f32_32x32x16_bf16 v[176:191], v[128:131], v[104:107], v[176:191]
    ds_read_b64_tr_b16 v[114:115], v153 offset:23296
    ds_read_b64_tr_b16 v[116:117], v153 offset:34816
    s_waitcnt lgkmcnt(5)
    v_mfma_f32_32x32x16_bf16 v[192:207], v[132:135], v[104:107], v[192:207]
    ds_read_b64_tr_b16 v[118:119], v153 offset:35584
    ds_read_b64_tr_b16 v[120:121], v156 offset:22528
    s_waitcnt lgkmcnt(6)
    v_mfma_f32_32x32x16_bf16 v[208:223], v[124:127], v[108:111], v[208:223]
    ds_read_b64_tr_b16 v[122:123], v156 offset:23296
    ds_read_b128 v[100:103], v143 offset:4096
    v_mfma_f32_32x32x16_bf16 v[224:239], v[128:131], v[108:111], v[224:239]
    v_mfma_f32_32x32x16_bf16 v[240:255], v[132:135], v[108:111], v[240:255]
    s_waitcnt lgkmcnt(5)
    v_mfma_f32_32x32x16_bf16 v[160:175], v[112:115], v[96:99], v[160:175]
    ds_read_b128 v[104:107], v144 offset:0
    ds_read_b64_tr_b16 v[124:125], v153 offset:25600
    s_waitcnt lgkmcnt(5)
    v_mfma_f32_32x32x16_bf16 v[176:191], v[116:119], v[96:99], v[176:191]
    ds_read_b64_tr_b16 v[126:127], v153 offset:26368
    ds_read_b64_tr_b16 v[128:129], v153 offset:37888
    s_waitcnt lgkmcnt(5)
    v_mfma_f32_32x32x16_bf16 v[192:207], v[120:123], v[96:99], v[192:207]
    ds_read_b64_tr_b16 v[130:131], v153 offset:38656
    ds_read_b64_tr_b16 v[132:133], v156 offset:25600
    s_waitcnt lgkmcnt(6)
    v_mfma_f32_32x32x16_bf16 v[208:223], v[112:115], v[100:103], v[208:223]
    ds_read_b64_tr_b16 v[134:135], v156 offset:26368
    ds_read_b128 v[108:111], v144 offset:4096
    v_mfma_f32_32x32x16_bf16 v[224:239], v[116:119], v[100:103], v[224:239]
    v_mfma_f32_32x32x16_bf16 v[240:255], v[120:123], v[100:103], v[240:255]
    s_waitcnt vmcnt(0)
    s_waitcnt lgkmcnt(0)
    s_barrier
    v_mfma_f32_32x32x16_bf16 v[160:175], v[124:127], v[104:107], v[160:175]
    ds_read_b128 v[96:99], v145 offset:0
    ds_read_b64_tr_b16 v[112:113], v154 offset:16384
    v_mfma_f32_32x32x16_bf16 v[176:191], v[128:131], v[104:107], v[176:191]
    ds_read_b64_tr_b16 v[114:115], v154 offset:17152
    ds_read_b64_tr_b16 v[116:117], v154 offset:28672
    v_mfma_f32_32x32x16_bf16 v[192:207], v[132:135], v[104:107], v[192:207]
    ds_read_b64_tr_b16 v[118:119], v154 offset:29440
    ds_read_b64_tr_b16 v[120:121], v157 offset:16384
    v_mfma_f32_32x32x16_bf16 v[208:223], v[124:127], v[108:111], v[208:223]
    ds_read_b64_tr_b16 v[122:123], v157 offset:17152
    ds_read_b128 v[100:103], v145 offset:4096
    v_mfma_f32_32x32x16_bf16 v[224:239], v[128:131], v[108:111], v[224:239]
    v_mfma_f32_32x32x16_bf16 v[240:255], v[132:135], v[108:111], v[240:255]
    s_waitcnt lgkmcnt(5)
    v_mfma_f32_32x32x16_bf16 v[160:175], v[112:115], v[96:99], v[160:175]
    ds_read_b128 v[104:107], v146 offset:0
    ds_read_b64_tr_b16 v[124:125], v154 offset:19456
    s_waitcnt lgkmcnt(5)
    v_mfma_f32_32x32x16_bf16 v[176:191], v[116:119], v[96:99], v[176:191]
    ds_read_b64_tr_b16 v[126:127], v154 offset:20224
    ds_read_b64_tr_b16 v[128:129], v154 offset:31744
    s_waitcnt lgkmcnt(5)
    v_mfma_f32_32x32x16_bf16 v[192:207], v[120:123], v[96:99], v[192:207]
    ds_read_b64_tr_b16 v[130:131], v154 offset:32512
    ds_read_b64_tr_b16 v[132:133], v157 offset:19456
    s_waitcnt lgkmcnt(6)
    v_mfma_f32_32x32x16_bf16 v[208:223], v[112:115], v[100:103], v[208:223]
    ds_read_b64_tr_b16 v[134:135], v157 offset:20224
    ds_read_b128 v[108:111], v146 offset:4096
    v_mfma_f32_32x32x16_bf16 v[224:239], v[116:119], v[100:103], v[224:239]
    v_mfma_f32_32x32x16_bf16 v[240:255], v[120:123], v[100:103], v[240:255]
    s_waitcnt lgkmcnt(5)
    v_mfma_f32_32x32x16_bf16 v[160:175], v[124:127], v[104:107], v[160:175]
    ds_read_b128 v[96:99], v147 offset:0
    ds_read_b64_tr_b16 v[112:113], v154 offset:22528
    s_waitcnt lgkmcnt(5)
    v_mfma_f32_32x32x16_bf16 v[176:191], v[128:131], v[104:107], v[176:191]
    ds_read_b64_tr_b16 v[114:115], v154 offset:23296
    ds_read_b64_tr_b16 v[116:117], v154 offset:34816
    s_waitcnt lgkmcnt(5)
    v_mfma_f32_32x32x16_bf16 v[192:207], v[132:135], v[104:107], v[192:207]
    ds_read_b64_tr_b16 v[118:119], v154 offset:35584
    ds_read_b64_tr_b16 v[120:121], v157 offset:22528
    s_waitcnt lgkmcnt(6)
    v_mfma_f32_32x32x16_bf16 v[208:223], v[124:127], v[108:111], v[208:223]
    ds_read_b64_tr_b16 v[122:123], v157 offset:23296
    ds_read_b128 v[100:103], v147 offset:4096
    v_mfma_f32_32x32x16_bf16 v[224:239], v[128:131], v[108:111], v[224:239]
    v_mfma_f32_32x32x16_bf16 v[240:255], v[132:135], v[108:111], v[240:255]
    s_waitcnt lgkmcnt(5)
    v_mfma_f32_32x32x16_bf16 v[160:175], v[112:115], v[96:99], v[160:175]
    ds_read_b128 v[104:107], v148 offset:0
    ds_read_b64_tr_b16 v[124:125], v154 offset:25600
    s_waitcnt lgkmcnt(5)
    v_mfma_f32_32x32x16_bf16 v[176:191], v[116:119], v[96:99], v[176:191]
    ds_read_b64_tr_b16 v[126:127], v154 offset:26368
    ds_read_b64_tr_b16 v[128:129], v154 offset:37888
    s_waitcnt lgkmcnt(5)
    v_mfma_f32_32x32x16_bf16 v[192:207], v[120:123], v[96:99], v[192:207]
    ds_read_b64_tr_b16 v[130:131], v154 offset:38656
    ds_read_b64_tr_b16 v[132:133], v157 offset:25600
    s_waitcnt lgkmcnt(6)
    v_mfma_f32_32x32x16_bf16 v[208:223], v[112:115], v[100:103], v[208:223]
    ds_read_b64_tr_b16 v[134:135], v157 offset:26368
    ds_read_b128 v[108:111], v148 offset:4096
    v_mfma_f32_32x32x16_bf16 v[224:239], v[116:119], v[100:103], v[224:239]
    v_mfma_f32_32x32x16_bf16 v[240:255], v[120:123], v[100:103], v[240:255]
    s_waitcnt lgkmcnt(5)
    v_mfma_f32_32x32x16_bf16 v[160:175], v[124:127], v[104:107], v[160:175]
    s_waitcnt lgkmcnt(3)
    v_mfma_f32_32x32x16_bf16 v[176:191], v[128:131], v[104:107], v[176:191]
    s_waitcnt lgkmcnt(1)
    v_mfma_f32_32x32x16_bf16 v[192:207], v[132:135], v[104:107], v[192:207]
    s_waitcnt lgkmcnt(0)
    v_mfma_f32_32x32x16_bf16 v[208:223], v[124:127], v[108:111], v[208:223]
    v_mfma_f32_32x32x16_bf16 v[224:239], v[128:131], v[108:111], v[224:239]
    v_mfma_f32_32x32x16_bf16 v[240:255], v[132:135], v[108:111], v[240:255]
    v_lshlrev_b32 v3, 4, v159
    s_lshl_b32 s38, s56, 2
    s_lshl_b32 s39, s58, 1
    s_add_u32 s38, s38, s39
    s_mul_i32 s38, s38, 86
    s_mul_i32 s39, s57, 6
    s_mul_i32 s40, s59, 3
    s_add_u32 s39, s39, s40
    s_add_u32 s38, s38, s39
    s_lshl_b32 s38, s38, 10
    s_lshl_b32 s39, s39, 4
    s_cmp_ge_u32 s39, 1376
    s_cbranch_scc1 G1END_3
    v_cvt_pk_bf16_f32 v8, v160, v161
    v_lshlrev_b32 v4, 16, v8
    v_and_b32 v5, 0xffff0000, v8
    v_mul_f32 v6, 0xbfb8aa3b, v4
    v_mul_f32 v7, 0xbfb8aa3b, v5
    v_exp_f32 v6, v6
    v_exp_f32 v7, v7
    v_add_f32 v6, 1.0, v6
    v_add_f32 v7, 1.0, v7
    v_rcp_f32 v6, v6
    v_rcp_f32 v7, v7
    v_mul_f32 v6, v4, v6
    v_mul_f32 v7, v5, v7
    v_cvt_pk_bf16_f32 v8, v6, v7
    v_lshlrev_b32 v6, 16, v8
    v_and_b32 v7, 0xffff0000, v8
    v_cvt_pk_bf16_f32 v8, v176, v177
    v_lshlrev_b32 v4, 16, v8
    v_and_b32 v5, 0xffff0000, v8
    v_mul_f32 v6, v6, v4
    v_mul_f32 v7, v7, v5
    v_cvt_pk_bf16_f32 v20, v6, v7
    v_cvt_pk_bf16_f32 v8, v162, v163
    v_lshlrev_b32 v4, 16, v8
    v_and_b32 v5, 0xffff0000, v8
    v_mul_f32 v6, 0xbfb8aa3b, v4
    v_mul_f32 v7, 0xbfb8aa3b, v5
    v_exp_f32 v6, v6
    v_exp_f32 v7, v7
    v_add_f32 v6, 1.0, v6
    v_add_f32 v7, 1.0, v7
    v_rcp_f32 v6, v6
    v_rcp_f32 v7, v7
    v_mul_f32 v6, v4, v6
    v_mul_f32 v7, v5, v7
    v_cvt_pk_bf16_f32 v8, v6, v7
    v_lshlrev_b32 v6, 16, v8
    v_and_b32 v7, 0xffff0000, v8
    v_cvt_pk_bf16_f32 v8, v178, v179
    v_lshlrev_b32 v4, 16, v8
    v_and_b32 v5, 0xffff0000, v8
    v_mul_f32 v6, v6, v4
    v_mul_f32 v7, v7, v5
    v_cvt_pk_bf16_f32 v21, v6, v7
    v_cvt_pk_bf16_f32 v8, v164, v165
    v_lshlrev_b32 v4, 16, v8
    v_and_b32 v5, 0xffff0000, v8
    v_mul_f32 v6, 0xbfb8aa3b, v4
    v_mul_f32 v7, 0xbfb8aa3b, v5
    v_exp_f32 v6, v6
    v_exp_f32 v7, v7
    v_add_f32 v6, 1.0, v6
    v_add_f32 v7, 1.0, v7
    v_rcp_f32 v6, v6
    v_rcp_f32 v7, v7
    v_mul_f32 v6, v4, v6
    v_mul_f32 v7, v5, v7
    v_cvt_pk_bf16_f32 v8, v6, v7
    v_lshlrev_b32 v6, 16, v8
    v_and_b32 v7, 0xffff0000, v8
    v_cvt_pk_bf16_f32 v8, v180, v181
    v_lshlrev_b32 v4, 16, v8
    v_and_b32 v5, 0xffff0000, v8
    v_mul_f32 v6, v6, v4
    v_mul_f32 v7, v7, v5
    v_cvt_pk_bf16_f32 v22, v6, v7
    v_cvt_pk_bf16_f32 v8, v166, v167
    v_lshlrev_b32 v4, 16, v8
    v_and_b32 v5, 0xffff0000, v8
    v_mul_f32 v6, 0xbfb8aa3b, v4
    v_mul_f32 v7, 0xbfb8aa3b, v5
    v_exp_f32 v6, v6
    v_exp_f32 v7, v7
    v_add_f32 v6, 1.0, v6
    v_add_f32 v7, 1.0, v7
    v_rcp_f32 v6, v6
    v_rcp_f32 v7, v7
    v_mul_f32 v6, v4, v6
    v_mul_f32 v7, v5, v7
    v_cvt_pk_bf16_f32 v8, v6, v7
    v_lshlrev_b32 v6, 16, v8
    v_and_b32 v7, 0xffff0000, v8
    v_cvt_pk_bf16_f32 v8, v182, v183
    v_lshlrev_b32 v4, 16, v8
    v_and_b32 v5, 0xffff0000, v8
    v_mul_f32 v6, v6, v4
    v_mul_f32 v7, v7, v5
    v_cvt_pk_bf16_f32 v23, v6, v7
    v_cvt_pk_bf16_f32 v8, v168, v169
    v_lshlrev_b32 v4, 16, v8
    v_and_b32 v5, 0xffff0000, v8
    v_mul_f32 v6, 0xbfb8aa3b, v4
    v_mul_f32 v7, 0xbfb8aa3b, v5
    v_exp_f32 v6, v6
    v_exp_f32 v7, v7
    v_add_f32 v6, 1.0, v6
    v_add_f32 v7, 1.0, v7
    v_rcp_f32 v6, v6
    v_rcp_f32 v7, v7
    v_mul_f32 v6, v4, v6
    v_mul_f32 v7, v5, v7
    v_cvt_pk_bf16_f32 v8, v6, v7
    v_lshlrev_b32 v6, 16, v8
    v_and_b32 v7, 0xffff0000, v8
    v_cvt_pk_bf16_f32 v8, v184, v185
    v_lshlrev_b32 v4, 16, v8
    v_and_b32 v5, 0xffff0000, v8
    v_mul_f32 v6, v6, v4
    v_mul_f32 v7, v7, v5
    v_cvt_pk_bf16_f32 v24, v6, v7
    v_cvt_pk_bf16_f32 v8, v170, v171
    v_lshlrev_b32 v4, 16, v8
    v_and_b32 v5, 0xffff0000, v8
    v_mul_f32 v6, 0xbfb8aa3b, v4
    v_mul_f32 v7, 0xbfb8aa3b, v5
    v_exp_f32 v6, v6
    v_exp_f32 v7, v7
    v_add_f32 v6, 1.0, v6
    v_add_f32 v7, 1.0, v7
    v_rcp_f32 v6, v6
    v_rcp_f32 v7, v7
    v_mul_f32 v6, v4, v6
    v_mul_f32 v7, v5, v7
    v_cvt_pk_bf16_f32 v8, v6, v7
    v_lshlrev_b32 v6, 16, v8
    v_and_b32 v7, 0xffff0000, v8
    v_cvt_pk_bf16_f32 v8, v186, v187
    v_lshlrev_b32 v4, 16, v8
    v_and_b32 v5, 0xffff0000, v8
    v_mul_f32 v6, v6, v4
    v_mul_f32 v7, v7, v5
    v_cvt_pk_bf16_f32 v25, v6, v7
    v_cvt_pk_bf16_f32 v8, v172, v173
    v_lshlrev_b32 v4, 16, v8
    v_and_b32 v5, 0xffff0000, v8
    v_mul_f32 v6, 0xbfb8aa3b, v4
    v_mul_f32 v7, 0xbfb8aa3b, v5
    v_exp_f32 v6, v6
    v_exp_f32 v7, v7
    v_add_f32 v6, 1.0, v6
    v_add_f32 v7, 1.0, v7
    v_rcp_f32 v6, v6
    v_rcp_f32 v7, v7
    v_mul_f32 v6, v4, v6
    v_mul_f32 v7, v5, v7
    v_cvt_pk_bf16_f32 v8, v6, v7
    v_lshlrev_b32 v6, 16, v8
    v_and_b32 v7, 0xffff0000, v8
    v_cvt_pk_bf16_f32 v8, v188, v189
    v_lshlrev_b32 v4, 16, v8
    v_and_b32 v5, 0xffff0000, v8
    v_mul_f32 v6, v6, v4
    v_mul_f32 v7, v7, v5
    v_cvt_pk_bf16_f32 v26, v6, v7
    v_cvt_pk_bf16_f32 v8, v174, v175
    v_lshlrev_b32 v4, 16, v8
    v_and_b32 v5, 0xffff0000, v8
    v_mul_f32 v6, 0xbfb8aa3b, v4
    v_mul_f32 v7, 0xbfb8aa3b, v5
    v_exp_f32 v6, v6
    v_exp_f32 v7, v7
    v_add_f32 v6, 1.0, v6
    v_add_f32 v7, 1.0, v7
    v_rcp_f32 v6, v6
    v_rcp_f32 v7, v7
    v_mul_f32 v6, v4, v6
    v_mul_f32 v7, v5, v7
    v_cvt_pk_bf16_f32 v8, v6, v7
    v_lshlrev_b32 v6, 16, v8
    v_and_b32 v7, 0xffff0000, v8
    v_cvt_pk_bf16_f32 v8, v190, v191
    v_lshlrev_b32 v4, 16, v8
    v_and_b32 v5, 0xffff0000, v8
    v_mul_f32 v6, v6, v4
    v_mul_f32 v7, v7, v5
    v_cvt_pk_bf16_f32 v27, v6, v7
    v_permlane32_swap_b32 v20, v22
    v_permlane32_swap_b32 v21, v23
    v_permlane32_swap_b32 v24, v26
    v_permlane32_swap_b32 v25, v27
    s_add_u32 s41, s38, 0
    buffer_store_dwordx4 v[20:23], v3, s[68:71], s41 offen offset:0
    buffer_store_dwordx4 v[24:27], v3, s[68:71], s41 offen offset:1024
    v_cvt_pk_bf16_f32 v8, v208, v209
    v_lshlrev_b32 v4, 16, v8
    v_and_b32 v5, 0xffff0000, v8
    v_mul_f32 v6, 0xbfb8aa3b, v4
    v_mul_f32 v7, 0xbfb8aa3b, v5
    v_exp_f32 v6, v6
    v_exp_f32 v7, v7
    v_add_f32 v6, 1.0, v6
    v_add_f32 v7, 1.0, v7
    v_rcp_f32 v6, v6
    v_rcp_f32 v7, v7
    v_mul_f32 v6, v4, v6
    v_mul_f32 v7, v5, v7
    v_cvt_pk_bf16_f32 v8, v6, v7
    v_lshlrev_b32 v6, 16, v8
    v_and_b32 v7, 0xffff0000, v8
    v_cvt_pk_bf16_f32 v8, v224, v225
    v_lshlrev_b32 v4, 16, v8
    v_and_b32 v5, 0xffff0000, v8
    v_mul_f32 v6, v6, v4
    v_mul_f32 v7, v7, v5
    v_cvt_pk_bf16_f32 v28, v6, v7
    v_cvt_pk_bf16_f32 v8, v210, v211
    v_lshlrev_b32 v4, 16, v8
    v_and_b32 v5, 0xffff0000, v8
    v_mul_f32 v6, 0xbfb8aa3b, v4
    v_mul_f32 v7, 0xbfb8aa3b, v5
    v_exp_f32 v6, v6
    v_exp_f32 v7, v7
    v_add_f32 v6, 1.0, v6
    v_add_f32 v7, 1.0, v7
    v_rcp_f32 v6, v6
    v_rcp_f32 v7, v7
    v_mul_f32 v6, v4, v6
    v_mul_f32 v7, v5, v7
    v_cvt_pk_bf16_f32 v8, v6, v7
    v_lshlrev_b32 v6, 16, v8
    v_and_b32 v7, 0xffff0000, v8
    v_cvt_pk_bf16_f32 v8, v226, v227
    v_lshlrev_b32 v4, 16, v8
    v_and_b32 v5, 0xffff0000, v8
    v_mul_f32 v6, v6, v4
    v_mul_f32 v7, v7, v5
    v_cvt_pk_bf16_f32 v29, v6, v7
    v_cvt_pk_bf16_f32 v8, v212, v213
    v_lshlrev_b32 v4, 16, v8
    v_and_b32 v5, 0xffff0000, v8
    v_mul_f32 v6, 0xbfb8aa3b, v4
    v_mul_f32 v7, 0xbfb8aa3b, v5
    v_exp_f32 v6, v6
    v_exp_f32 v7, v7
    v_add_f32 v6, 1.0, v6
    v_add_f32 v7, 1.0, v7
    v_rcp_f32 v6, v6
    v_rcp_f32 v7, v7
    v_mul_f32 v6, v4, v6
    v_mul_f32 v7, v5, v7
    v_cvt_pk_bf16_f32 v8, v6, v7
    v_lshlrev_b32 v6, 16, v8
    v_and_b32 v7, 0xffff0000, v8
    v_cvt_pk_bf16_f32 v8, v228, v229
    v_lshlrev_b32 v4, 16, v8
    v_and_b32 v5, 0xffff0000, v8
    v_mul_f32 v6, v6, v4
    v_mul_f32 v7, v7, v5
    v_cvt_pk_bf16_f32 v30, v6, v7
    v_cvt_pk_bf16_f32 v8, v214, v215
    v_lshlrev_b32 v4, 16, v8
    v_and_b32 v5, 0xffff0000, v8
    v_mul_f32 v6, 0xbfb8aa3b, v4
    v_mul_f32 v7, 0xbfb8aa3b, v5
    v_exp_f32 v6, v6
    v_exp_f32 v7, v7
    v_add_f32 v6, 1.0, v6
    v_add_f32 v7, 1.0, v7
    v_rcp_f32 v6, v6
    v_rcp_f32 v7, v7
    v_mul_f32 v6, v4, v6
    v_mul_f32 v7, v5, v7
    v_cvt_pk_bf16_f32 v8, v6, v7
    v_lshlrev_b32 v6, 16, v8
    v_and_b32 v7, 0xffff0000, v8
    v_cvt_pk_bf16_f32 v8, v230, v231
    v_lshlrev_b32 v4, 16, v8
    v_and_b32 v5, 0xffff0000, v8
    v_mul_f32 v6, v6, v4
    v_mul_f32 v7, v7, v5
    v_cvt_pk_bf16_f32 v31, v6, v7
    v_cvt_pk_bf16_f32 v8, v216, v217
    v_lshlrev_b32 v4, 16, v8
    v_and_b32 v5, 0xffff0000, v8
    v_mul_f32 v6, 0xbfb8aa3b, v4
    v_mul_f32 v7, 0xbfb8aa3b, v5
    v_exp_f32 v6, v6
    v_exp_f32 v7, v7
    v_add_f32 v6, 1.0, v6
    v_add_f32 v7, 1.0, v7
    v_rcp_f32 v6, v6
    v_rcp_f32 v7, v7
    v_mul_f32 v6, v4, v6
    v_mul_f32 v7, v5, v7
    v_cvt_pk_bf16_f32 v8, v6, v7
    v_lshlrev_b32 v6, 16, v8
    v_and_b32 v7, 0xffff0000, v8
    v_cvt_pk_bf16_f32 v8, v232, v233
    v_lshlrev_b32 v4, 16, v8
    v_and_b32 v5, 0xffff0000, v8
    v_mul_f32 v6, v6, v4
    v_mul_f32 v7, v7, v5
    v_cvt_pk_bf16_f32 v32, v6, v7
    v_cvt_pk_bf16_f32 v8, v218, v219
    v_lshlrev_b32 v4, 16, v8
    v_and_b32 v5, 0xffff0000, v8
    v_mul_f32 v6, 0xbfb8aa3b, v4
    v_mul_f32 v7, 0xbfb8aa3b, v5
    v_exp_f32 v6, v6
    v_exp_f32 v7, v7
    v_add_f32 v6, 1.0, v6
    v_add_f32 v7, 1.0, v7
    v_rcp_f32 v6, v6
    v_rcp_f32 v7, v7
    v_mul_f32 v6, v4, v6
    v_mul_f32 v7, v5, v7
    v_cvt_pk_bf16_f32 v8, v6, v7
    v_lshlrev_b32 v6, 16, v8
    v_and_b32 v7, 0xffff0000, v8
    v_cvt_pk_bf16_f32 v8, v234, v235
    v_lshlrev_b32 v4, 16, v8
    v_and_b32 v5, 0xffff0000, v8
    v_mul_f32 v6, v6, v4
    v_mul_f32 v7, v7, v5
    v_cvt_pk_bf16_f32 v33, v6, v7
    v_cvt_pk_bf16_f32 v8, v220, v221
    v_lshlrev_b32 v4, 16, v8
    v_and_b32 v5, 0xffff0000, v8
    v_mul_f32 v6, 0xbfb8aa3b, v4
    v_mul_f32 v7, 0xbfb8aa3b, v5
    v_exp_f32 v6, v6
    v_exp_f32 v7, v7
    v_add_f32 v6, 1.0, v6
    v_add_f32 v7, 1.0, v7
    v_rcp_f32 v6, v6
    v_rcp_f32 v7, v7
    v_mul_f32 v6, v4, v6
    v_mul_f32 v7, v5, v7
    v_cvt_pk_bf16_f32 v8, v6, v7
    v_lshlrev_b32 v6, 16, v8
    v_and_b32 v7, 0xffff0000, v8
    v_cvt_pk_bf16_f32 v8, v236, v237
    v_lshlrev_b32 v4, 16, v8
    v_and_b32 v5, 0xffff0000, v8
    v_mul_f32 v6, v6, v4
    v_mul_f32 v7, v7, v5
    v_cvt_pk_bf16_f32 v34, v6, v7
    v_cvt_pk_bf16_f32 v8, v222, v223
    v_lshlrev_b32 v4, 16, v8
    v_and_b32 v5, 0xffff0000, v8
    v_mul_f32 v6, 0xbfb8aa3b, v4
    v_mul_f32 v7, 0xbfb8aa3b, v5
    v_exp_f32 v6, v6
    v_exp_f32 v7, v7
    v_add_f32 v6, 1.0, v6
    v_add_f32 v7, 1.0, v7
    v_rcp_f32 v6, v6
    v_rcp_f32 v7, v7
    v_mul_f32 v6, v4, v6
    v_mul_f32 v7, v5, v7
    v_cvt_pk_bf16_f32 v8, v6, v7
    v_lshlrev_b32 v6, 16, v8
    v_and_b32 v7, 0xffff0000, v8
    v_cvt_pk_bf16_f32 v8, v238, v239
    v_lshlrev_b32 v4, 16, v8
    v_and_b32 v5, 0xffff0000, v8
    v_mul_f32 v6, v6, v4
    v_mul_f32 v7, v7, v5
    v_cvt_pk_bf16_f32 v35, v6, v7
    v_permlane32_swap_b32 v28, v30
    v_permlane32_swap_b32 v29, v31
    v_permlane32_swap_b32 v32, v34
    v_permlane32_swap_b32 v33, v35
    s_add_u32 s41, s38, 88064
    buffer_store_dwordx4 v[28:31], v3, s[68:71], s41 offen offset:0
    buffer_store_dwordx4 v[32:35], v3, s[68:71], s41 offen offset:1024
    s_add_u32 s39, s39, 32
    s_cmp_ge_u32 s39, 1376
    s_cbranch_scc1 G1END_3
    v_cvt_pk_bf16_f32 v8, v192, v193
    v_lshlrev_b32 v4, 16, v8
    v_and_b32 v5, 0xffff0000, v8
    v_mul_f32 v6, 0xbfb8aa3b, v4
    v_mul_f32 v7, 0xbfb8aa3b, v5
    v_exp_f32 v6, v6
    v_exp_f32 v7, v7
    v_add_f32 v6, 1.0, v6
    v_add_f32 v7, 1.0, v7
    v_rcp_f32 v6, v6
    v_rcp_f32 v7, v7
    v_mul_f32 v6, v4, v6
    v_mul_f32 v7, v5, v7
    v_cvt_pk_bf16_f32 v8, v6, v7
    v_lshlrev_b32 v6, 16, v8
    v_and_b32 v7, 0xffff0000, v8
    v_cvt_pk_bf16_f32 v8, v200, v201
    v_lshlrev_b32 v4, 16, v8
    v_and_b32 v5, 0xffff0000, v8
    v_mul_f32 v6, v6, v4
    v_mul_f32 v7, v7, v5
    v_cvt_pk_bf16_f32 v36, v6, v7
    v_cvt_pk_bf16_f32 v8, v194, v195
    v_lshlrev_b32 v4, 16, v8
    v_and_b32 v5, 0xffff0000, v8
    v_mul_f32 v6, 0xbfb8aa3b, v4
    v_mul_f32 v7, 0xbfb8aa3b, v5
    v_exp_f32 v6, v6
    v_exp_f32 v7, v7
    v_add_f32 v6, 1.0, v6
    v_add_f32 v7, 1.0, v7
    v_rcp_f32 v6, v6
    v_rcp_f32 v7, v7
    v_mul_f32 v6, v4, v6
    v_mul_f32 v7, v5, v7
    v_cvt_pk_bf16_f32 v8, v6, v7
    v_lshlrev_b32 v6, 16, v8
    v_and_b32 v7, 0xffff0000, v8
    v_cvt_pk_bf16_f32 v8, v202, v203
    v_lshlrev_b32 v4, 16, v8
    v_and_b32 v5, 0xffff0000, v8
    v_mul_f32 v6, v6, v4
    v_mul_f32 v7, v7, v5
    v_cvt_pk_bf16_f32 v37, v6, v7
    v_cvt_pk_bf16_f32 v8, v196, v197
    v_lshlrev_b32 v4, 16, v8
    v_and_b32 v5, 0xffff0000, v8
    v_mul_f32 v6, 0xbfb8aa3b, v4
    v_mul_f32 v7, 0xbfb8aa3b, v5
    v_exp_f32 v6, v6
    v_exp_f32 v7, v7
    v_add_f32 v6, 1.0, v6
    v_add_f32 v7, 1.0, v7
    v_rcp_f32 v6, v6
    v_rcp_f32 v7, v7
    v_mul_f32 v6, v4, v6
    v_mul_f32 v7, v5, v7
    v_cvt_pk_bf16_f32 v8, v6, v7
    v_lshlrev_b32 v6, 16, v8
    v_and_b32 v7, 0xffff0000, v8
    v_cvt_pk_bf16_f32 v8, v204, v205
    v_lshlrev_b32 v4, 16, v8
    v_and_b32 v5, 0xffff0000, v8
    v_mul_f32 v6, v6, v4
    v_mul_f32 v7, v7, v5
    v_cvt_pk_bf16_f32 v38, v6, v7
    v_cvt_pk_bf16_f32 v8, v198, v199
    v_lshlrev_b32 v4, 16, v8
    v_and_b32 v5, 0xffff0000, v8
    v_mul_f32 v6, 0xbfb8aa3b, v4
    v_mul_f32 v7, 0xbfb8aa3b, v5
    v_exp_f32 v6, v6
    v_exp_f32 v7, v7
    v_add_f32 v6, 1.0, v6
    v_add_f32 v7, 1.0, v7
    v_rcp_f32 v6, v6
    v_rcp_f32 v7, v7
    v_mul_f32 v6, v4, v6
    v_mul_f32 v7, v5, v7
    v_cvt_pk_bf16_f32 v8, v6, v7
    v_lshlrev_b32 v6, 16, v8
    v_and_b32 v7, 0xffff0000, v8
    v_cvt_pk_bf16_f32 v8, v206, v207
    v_lshlrev_b32 v4, 16, v8
    v_and_b32 v5, 0xffff0000, v8
    v_mul_f32 v6, v6, v4
    v_mul_f32 v7, v7, v5
    v_cvt_pk_bf16_f32 v39, v6, v7
    v_permlane32_swap_b32 v36, v38
    s_nop 0
    v_permlane32_swap_b32 v37, v39
    s_add_u32 s41, s38, 0
    buffer_store_dwordx4 v[36:39], v3, s[68:71], s41 offen offset:2048
    v_cvt_pk_bf16_f32 v8, v240, v241
    v_lshlrev_b32 v4, 16, v8
    v_and_b32 v5, 0xffff0000, v8
    v_mul_f32 v6, 0xbfb8aa3b, v4
    v_mul_f32 v7, 0xbfb8aa3b, v5
    v_exp_f32 v6, v6
    v_exp_f32 v7, v7
    v_add_f32 v6, 1.0, v6
    v_add_f32 v7, 1.0, v7
    v_rcp_f32 v6, v6
    v_rcp_f32 v7, v7
    v_mul_f32 v6, v4, v6
    v_mul_f32 v7, v5, v7
    v_cvt_pk_bf16_f32 v8, v6, v7
    v_lshlrev_b32 v6, 16, v8
    v_and_b32 v7, 0xffff0000, v8
    v_cvt_pk_bf16_f32 v8, v248, v249
    v_lshlrev_b32 v4, 16, v8
    v_and_b32 v5, 0xffff0000, v8
    v_mul_f32 v6, v6, v4
    v_mul_f32 v7, v7, v5
    v_cvt_pk_bf16_f32 v40, v6, v7
    v_cvt_pk_bf16_f32 v8, v242, v243
    v_lshlrev_b32 v4, 16, v8
    v_and_b32 v5, 0xffff0000, v8
    v_mul_f32 v6, 0xbfb8aa3b, v4
    v_mul_f32 v7, 0xbfb8aa3b, v5
    v_exp_f32 v6, v6
    v_exp_f32 v7, v7
    v_add_f32 v6, 1.0, v6
    v_add_f32 v7, 1.0, v7
    v_rcp_f32 v6, v6
    v_rcp_f32 v7, v7
    v_mul_f32 v6, v4, v6
    v_mul_f32 v7, v5, v7
    v_cvt_pk_bf16_f32 v8, v6, v7
    v_lshlrev_b32 v6, 16, v8
    v_and_b32 v7, 0xffff0000, v8
    v_cvt_pk_bf16_f32 v8, v250, v251
    v_lshlrev_b32 v4, 16, v8
    v_and_b32 v5, 0xffff0000, v8
    v_mul_f32 v6, v6, v4
    v_mul_f32 v7, v7, v5
    v_cvt_pk_bf16_f32 v41, v6, v7
    v_cvt_pk_bf16_f32 v8, v244, v245
    v_lshlrev_b32 v4, 16, v8
    v_and_b32 v5, 0xffff0000, v8
    v_mul_f32 v6, 0xbfb8aa3b, v4
    v_mul_f32 v7, 0xbfb8aa3b, v5
    v_exp_f32 v6, v6
    v_exp_f32 v7, v7
    v_add_f32 v6, 1.0, v6
    v_add_f32 v7, 1.0, v7
    v_rcp_f32 v6, v6
    v_rcp_f32 v7, v7
    v_mul_f32 v6, v4, v6
    v_mul_f32 v7, v5, v7
    v_cvt_pk_bf16_f32 v8, v6, v7
    v_lshlrev_b32 v6, 16, v8
    v_and_b32 v7, 0xffff0000, v8
    v_cvt_pk_bf16_f32 v8, v252, v253
    v_lshlrev_b32 v4, 16, v8
    v_and_b32 v5, 0xffff0000, v8
    v_mul_f32 v6, v6, v4
    v_mul_f32 v7, v7, v5
    v_cvt_pk_bf16_f32 v42, v6, v7
    v_cvt_pk_bf16_f32 v8, v246, v247
    v_lshlrev_b32 v4, 16, v8
    v_and_b32 v5, 0xffff0000, v8
    v_mul_f32 v6, 0xbfb8aa3b, v4
    v_mul_f32 v7, 0xbfb8aa3b, v5
    v_exp_f32 v6, v6
    v_exp_f32 v7, v7
    v_add_f32 v6, 1.0, v6
    v_add_f32 v7, 1.0, v7
    v_rcp_f32 v6, v6
    v_rcp_f32 v7, v7
    v_mul_f32 v6, v4, v6
    v_mul_f32 v7, v5, v7
    v_cvt_pk_bf16_f32 v8, v6, v7
    v_lshlrev_b32 v6, 16, v8
    v_and_b32 v7, 0xffff0000, v8
    v_cvt_pk_bf16_f32 v8, v254, v255
    v_lshlrev_b32 v4, 16, v8
    v_and_b32 v5, 0xffff0000, v8
    v_mul_f32 v6, v6, v4
    v_mul_f32 v7, v7, v5
    v_cvt_pk_bf16_f32 v43, v6, v7
    v_permlane32_swap_b32 v40, v42
    s_nop 0
    v_permlane32_swap_b32 v41, v43
    s_add_u32 s41, s38, 88064
    buffer_store_dwordx4 v[40:43], v3, s[68:71], s41 offen offset:2048
G1END_3:
    s_endpgm
K1_PACK:
    v_and_b32 v88, 63, v0
    v_lshlrev_b32 v89, 4, v88
    s_bfe_u32 s98, s4, 0x10002
    s_lshl_b32 s98, s98, 10
    s_lshr_b32 s99, s4, 3
    s_lshl_b32 s99, s99, 5
    s_add_u32 s98, s98, s99
    s_lshl_b32 s99, s3, 3
    s_add_u32 s98, s98, s99
    s_lshl_b32 s98, s98, 10
    s_add_u32 s99, s98, 0
    buffer_load_dwordx4 v[92:95], v89, s[16:19], s99 offen
    s_add_u32 s99, s98, 1024
    buffer_load_dwordx4 v[92:95], v89, s[16:19], s99 offen
    s_add_u32 s99, s98, 2048
    buffer_load_dwordx4 v[92:95], v89, s[16:19], s99 offen
    s_add_u32 s99, s98, 3072
    buffer_load_dwordx4 v[92:95], v89, s[16:19], s99 offen
    s_add_u32 s99, s98, 4096
    buffer_load_dwordx4 v[92:95], v89, s[16:19], s99 offen
    s_add_u32 s99, s98, 5120
    buffer_load_dwordx4 v[92:95], v89, s[16:19], s99 offen
    s_add_u32 s99, s98, 6144
    buffer_load_dwordx4 v[92:95], v89, s[16:19], s99 offen
    s_add_u32 s99, s98, 7168
    buffer_load_dwordx4 v[92:95], v89, s[16:19], s99 offen
    s_lshr_b32 s98, s4, 3
    s_lshl_b32 s98, s98, 4
    s_and_b32 s99, s3, 1
    s_lshl_b32 s99, s99, 3
    s_add_u32 s98, s98, s99
    s_mul_i32 s98, s98, 2752
    s_and_b32 s99, s4, 3
    s_mul_i32 s99, s99, 768
    s_add_u32 s98, s98, s99
    s_movk_i32 s99, 2752
    v_add_u32 v90, 0, v88
    v_mul_u32_u24 v91, 21846, v90
    v_lshrrev_b32 v91, 20, v91
    v_mul_u32_u24 v89, 48, v91
    v_sub_u32 v90, v90, v89
    v_mul_lo_u32 v91, v91, s99
    v_lshl_add_u32 v91, v90, 4, v91
    buffer_load_dwordx4 v[92:95], v91, s[64:67], s98 offen
    v_add_u32 v90, 64, v88
    v_mul_u32_u24 v91, 21846, v90
    v_lshrrev_b32 v91, 20, v91
    v_mul_u32_u24 v89, 48, v91
    v_sub_u32 v90, v90, v89
    v_mul_lo_u32 v91, v91, s99
    v_lshl_add_u32 v91, v90, 4, v91
    buffer_load_dwordx4 v[92:95], v91, s[64:67], s98 offen
    v_add_u32 v90, 128, v88
    v_mul_u32_u24 v91, 21846, v90
    v_lshrrev_b32 v91, 20, v91
    v_mul_u32_u24 v89, 48, v91
    v_sub_u32 v90, v90, v89
    v_mul_lo_u32 v91, v91, s99
    v_lshl_add_u32 v91, v90, 4, v91
    buffer_load_dwordx4 v[92:95], v91, s[64:67], s98 offen
    v_add_u32 v90, 192, v88
    v_mul_u32_u24 v91, 21846, v90
    v_lshrrev_b32 v91, 20, v91
    v_mul_u32_u24 v89, 48, v91
    v_sub_u32 v90, v90, v89
    v_mul_lo_u32 v91, v91, s99
    v_lshl_add_u32 v91, v90, 4, v91
    buffer_load_dwordx4 v[92:95], v91, s[64:67], s98 offen
    v_add_u32 v90, 256, v88
    v_mul_u32_u24 v91, 21846, v90
    v_lshrrev_b32 v91, 20, v91
    v_mul_u32_u24 v89, 48, v91
    v_sub_u32 v90, v90, v89
    v_mul_lo_u32 v91, v91, s99
    v_lshl_add_u32 v91, v90, 4, v91
    buffer_load_dwordx4 v[92:95], v91, s[64:67], s98 offen
    v_add_u32 v90, 320, v88
    v_mul_u32_u24 v91, 21846, v90
    v_lshrrev_b32 v91, 20, v91
    v_mul_u32_u24 v89, 48, v91
    v_sub_u32 v90, v90, v89
    v_mul_lo_u32 v91, v91, s99
    v_lshl_add_u32 v91, v90, 4, v91
    buffer_load_dwordx4 v[92:95], v91, s[64:67], s98 offen
    v_and_b32 v1, 63, v0
    v_lshrrev_b32 v2, 6, v0
    s_lshl_b32 s14, s2, 3
    s_lshl_b32 s15, s3, 1
    s_add_u32 s14, s14, s15
    s_lshl_b32 s15, s14, 10
    s_add_u32 s28, s15, 1024
    v_lshlrev_b32 v3, 4, v1
    s_mul_i32 s31, s3, 4608
    s_add_u32 m0, s31, 122880
    s_nop 0
    buffer_load_dwordx4 v3, s[16:19], s15 offen lds
    s_add_u32 m0, s31, 123904
    s_nop 0
    buffer_load_dwordx4 v3, s[16:19], s28 offen lds
    s_add_u32 m0, s31, 124928
    s_nop 0
    buffer_load_dwordx4 v3, s[20:23], 0 offen lds
    s_lshr_b32 s29, s2, 5
    s_bfe_u32 s31, s2, 0x30002
    s_lshl_b32 s31, s31, 3
    s_add_u32 s29, s29, s31
    s_and_b32 s31, s2, 3
    s_lshl_b32 s31, s31, 6
    s_add_u32 s29, s29, s31
    s_lshr_b32 s31, s3, 1
    s_lshl_b32 s31, s31, 8
    s_add_u32 s29, s29, s31
    s_and_b32 s31, s3, 1
    s_lshl_b32 s31, s31, 10
    s_add_u32 s29, s29, s31
    s_mul_i32 s29, s29, 514
    s_lshl_b32 s31, s3, 11
    s_add_u32 s49, s29, 0
    s_add_u32 m0, s31, 141312
    s_nop 0
    buffer_load_dwordx4 v3, s[36:39], s49 offen lds
    s_add_u32 m0, s31, 149504
    s_nop 0
    buffer_load_dwordx4 v3, s[40:43], s49 offen lds
    s_add_u32 s49, s29, 263168
    s_add_u32 m0, s31, 142336
    s_nop 0
    buffer_load_dwordx4 v3, s[36:39], s49 offen lds
    s_add_u32 m0, s31, 150528
    s_nop 0
    buffer_load_dwordx4 v3, s[40:43], s49 offen lds
    s_mov_b32 s72, s50
    s_mov_b32 s73, s51
    s_mov_b32 s74, 0x158000
    s_mov_b32 s75, 0x00020000
    s_add_u32 s76, s12, 0x1000000
    s_addc_u32 s77, s13, 0
    s_mov_b32 s78, 0x180000
    s_mov_b32 s79, 0x00020000
    s_mul_i32 s58, s56, 6
    v_lshrrev_b32 v228, 4, v0
    v_and_b32 v229, 15, v0
    v_lshlrev_b32 v224, 10, v228
    v_lshl_add_u32 v224, v229, 4, v224
    v_mul_u32_u24 v225, 1088, v228
    v_lshl_add_u32 v225, v229, 4, v225
    s_add_u32 s96, s58, 0
    s_lshl_b32 s96, s96, 14
    buffer_load_dwordx4 v[128:131], v224, s[72:75], s96 offen offset:0
    buffer_load_dwordx4 v[132:135], v224, s[72:75], s96 offen offset:256
    buffer_load_dwordx4 v[136:139], v224, s[72:75], s96 offen offset:512
    buffer_load_dwordx4 v[140:143], v224, s[72:75], s96 offen offset:768
    s_add_u32 s96, s58, 1
    s_lshl_b32 s96, s96, 14
    buffer_load_dwordx4 v[144:147], v224, s[72:75], s96 offen offset:0
    buffer_load_dwordx4 v[148:151], v224, s[72:75], s96 offen offset:256
    buffer_load_dwordx4 v[152:155], v224, s[72:75], s96 offen offset:512
    buffer_load_dwordx4 v[156:159], v224, s[72:75], s96 offen offset:768
    s_add_u32 s96, s58, 2
    s_lshl_b32 s96, s96, 14
    buffer_load_dwordx4 v[160:163], v224, s[72:75], s96 offen offset:0
    buffer_load_dwordx4 v[164:167], v224, s[72:75], s96 offen offset:256
    buffer_load_dwordx4 v[168:171], v224, s[72:75], s96 offen offset:512
    buffer_load_dwordx4 v[172:175], v224, s[72:75], s96 offen offset:768
    s_add_u32 s96, s58, 3
    s_lshl_b32 s96, s96, 14
    buffer_load_dwordx4 v[176:179], v224, s[72:75], s96 offen offset:0
    buffer_load_dwordx4 v[180:183], v224, s[72:75], s96 offen offset:256
    buffer_load_dwordx4 v[184:187], v224, s[72:75], s96 offen offset:512
    buffer_load_dwordx4 v[188:191], v224, s[72:75], s96 offen offset:768
    s_add_u32 s96, s58, 4
    s_lshl_b32 s96, s96, 14
    buffer_load_dwordx4 v[192:195], v224, s[72:75], s96 offen offset:0
    buffer_load_dwordx4 v[196:199], v224, s[72:75], s96 offen offset:256
    buffer_load_dwordx4 v[200:203], v224, s[72:75], s96 offen offset:512
    buffer_load_dwordx4 v[204:207], v224, s[72:75], s96 offen offset:768
    s_add_u32 s96, s58, 5
    s_lshl_b32 s96, s96, 14
    buffer_load_dwordx4 v[208:211], v224, s[72:75], s96 offen offset:0
    buffer_load_dwordx4 v[212:215], v224, s[72:75], s96 offen offset:256
    buffer_load_dwordx4 v[216:219], v224, s[72:75], s96 offen offset:512
    buffer_load_dwordx4 v[220:223], v224, s[72:75], s96 offen offset:768
    v_mul_u32_u24 v3, 4608, v2
    v_add_u32 v3, 122880, v3
    v_lshl_add_u32 v4, v1, 3, v3
    v_lshrrev_b32 v7, 3, v1
    v_and_b32 v8, 7, v1
    v_mul_u32_u24 v7, 72, v7
    v_add_u32 v5, v7, v8
    v_lshl_add_u32 v5, v5, 3, v3
    v_mul_u32_u24 v6, 9, v8
    v_add_u32 v6, v6, v7
    v_lshl_add_u32 v6, v6, 3, v3
    v_cvt_f32_u32 v9, v1
    v_mul_f32 v11, 0x3b000000, v9
    v_fract_f32 v11, v11
    v_cos_f32 v10, v11
    v_sin_f32 v11, v11
    v_mul_f32 v13, 0x3b800000, v9
    v_fract_f32 v13, v13
    v_cos_f32 v12, v13
    v_sin_f32 v13, v13
    v_mul_f32 v15, 0x3bc00000, v9
    v_fract_f32 v15, v15
    v_cos_f32 v14, v15
    v_sin_f32 v15, v15
    v_mul_f32 v17, 0x3c000000, v9
    v_fract_f32 v17, v17
    v_cos_f32 v16, v17
    v_sin_f32 v17, v17
    v_mul_f32 v19, 0x3c200000, v9
    v_fract_f32 v19, v19
    v_cos_f32 v18, v19
    v_sin_f32 v19, v19
    v_mul_f32 v21, 0x3c400000, v9
    v_fract_f32 v21, v21
    v_cos_f32 v20, v21
    v_sin_f32 v21, v21
    v_mul_f32 v23, 0x3c600000, v9
    v_fract_f32 v23, v23
    v_cos_f32 v22, v23
    v_sin_f32 v23, v23
    v_cvt_f32_u32 v9, v8
    v_mul_f32 v25, 0x3c800000, v9
    v_fract_f32 v25, v25
    v_cos_f32 v24, v25
    v_sin_f32 v25, v25
    v_mul_f32 v27, 0x3d000000, v9
    v_fract_f32 v27, v27
    v_cos_f32 v26, v27
    v_sin_f32 v27, v27
    v_mul_f32 v29, 0x3d400000, v9
    v_fract_f32 v29, v29
    v_cos_f32 v28, v29
    v_sin_f32 v29, v29
    v_mul_f32 v31, 0x3d800000, v9
    v_fract_f32 v31, v31
    v_cos_f32 v30, v31
    v_sin_f32 v31, v31
    v_mul_f32 v33, 0x3da00000, v9
    v_fract_f32 v33, v33
    v_cos_f32 v32, v33
    v_sin_f32 v33, v33
    v_mul_f32 v35, 0x3dc00000, v9
    v_fract_f32 v35, v35
    v_cos_f32 v34, v35
    v_sin_f32 v35, v35
    v_mul_f32 v37, 0x3de00000, v9
    v_fract_f32 v37, v37
    v_cos_f32 v36, v37
    v_sin_f32 v37, v37
    v_mov_b32 v8, 0
    v_mov_b32 v9, 0
    v_mov_b32 v7, 0
    v_mov_b32 v38, 0
    v_mov_b32 v39, 0
    v_mov_b32 v52, 0
    v_mov_b32 v40, 0
    v_mov_b32 v41, 0
    v_mov_b32 v53, 0
    v_mov_b32 v42, 0
    v_mov_b32 v43, 0
    v_mov_b32 v54, 0
    v_mov_b32 v44, 0
    v_mov_b32 v45, 0
    v_mov_b32 v55, 0
    v_mov_b32 v46, 0
    v_mov_b32 v47, 0
    v_mov_b32 v56, 0
    v_mov_b32 v48, 0
    v_mov_b32 v49, 0
    v_mov_b32 v57, 0
    v_mov_b32 v50, 0
    v_mov_b32 v51, 0
    v_mov_b32 v58, 0
    v_lshl_add_u32 v59, v1, 1, v3
    s_waitcnt vmcnt(28)
    ds_read_u16_d16_hi v8, v59 offset:0
    ds_read_u16_d16_hi v9, v59 offset:1024
    ds_read_u16_d16_hi v7, v59 offset:2048
    ds_read_u16_d16_hi v38, v59 offset:128
    ds_read_u16_d16_hi v39, v59 offset:1152
    ds_read_u16_d16_hi v52, v59 offset:2176
    ds_read_u16_d16_hi v40, v59 offset:256
    ds_read_u16_d16_hi v41, v59 offset:1280
    ds_read_u16_d16_hi v53, v59 offset:2304
    ds_read_u16_d16_hi v42, v59 offset:384
    ds_read_u16_d16_hi v43, v59 offset:1408
    ds_read_u16_d16_hi v54, v59 offset:2432
    ds_read_u16_d16_hi v44, v59 offset:512
    ds_read_u16_d16_hi v45, v59 offset:1536
    ds_read_u16_d16_hi v55, v59 offset:2560
    ds_read_u16_d16_hi v46, v59 offset:640
    ds_read_u16_d16_hi v47, v59 offset:1664
    ds_read_u16_d16_hi v56, v59 offset:2688
    ds_read_u16_d16_hi v48, v59 offset:768
    ds_read_u16_d16_hi v49, v59 offset:1792
    ds_read_u16_d16_hi v57, v59 offset:2816
    ds_read_u16_d16_hi v50, v59 offset:896
    ds_read_u16_d16_hi v51, v59 offset:1920
    ds_read_u16_d16_hi v58, v59 offset:2944
    s_waitcnt lgkmcnt(0)
    v_mul_f32 v61, v8, v7
    v_mul_f32 v62, v9, v7
    v_cvt_pk_bf16_f32 v63, v61, v62
    v_lshlrev_b32 v61, 16, v63
    v_and_b32 v62, 0xffff0000, v63
    v_mov_b32 v59, v61
    v_mov_b32 v60, v62
    v_mul_f32 v61, v38, v52
    v_mul_f32 v62, v39, v52
    v_cvt_pk_bf16_f32 v63, v61, v62
    v_lshlrev_b32 v61, 16, v63
    v_and_b32 v62, 0xffff0000, v63
    v_add_f32 v59, v59, v61
    v_add_f32 v60, v60, v62
    v_mul_f32 v61, v40, v53
    v_mul_f32 v62, v41, v53
    v_cvt_pk_bf16_f32 v63, v61, v62
    v_lshlrev_b32 v61, 16, v63
    v_and_b32 v62, 0xffff0000, v63
    v_add_f32 v59, v59, v61
    v_add_f32 v60, v60, v62
    v_mul_f32 v61, v42, v54
    v_mul_f32 v62, v43, v54
    v_cvt_pk_bf16_f32 v63, v61, v62
    v_lshlrev_b32 v61, 16, v63
    v_and_b32 v62, 0xffff0000, v63
    v_add_f32 v59, v59, v61
    v_add_f32 v60, v60, v62
    v_mul_f32 v61, v44, v55
    v_mul_f32 v62, v45, v55
    v_cvt_pk_bf16_f32 v63, v61, v62
    v_lshlrev_b32 v61, 16, v63
    v_and_b32 v62, 0xffff0000, v63
    v_add_f32 v59, v59, v61
    v_add_f32 v60, v60, v62
    v_mul_f32 v61, v46, v56
    v_mul_f32 v62, v47, v56
    v_cvt_pk_bf16_f32 v63, v61, v62
    v_lshlrev_b32 v61, 16, v63
    v_and_b32 v62, 0xffff0000, v63
    v_add_f32 v59, v59, v61
    v_add_f32 v60, v60, v62
    v_mul_f32 v61, v48, v57
    v_mul_f32 v62, v49, v57
    v_cvt_pk_bf16_f32 v63, v61, v62
    v_lshlrev_b32 v61, 16, v63
    v_and_b32 v62, 0xffff0000, v63
    v_add_f32 v59, v59, v61
    v_add_f32 v60, v60, v62
    v_mul_f32 v61, v50, v58
    v_mul_f32 v62, v51, v58
    v_cvt_pk_bf16_f32 v63, v61, v62
    v_lshlrev_b32 v61, 16, v63
    v_and_b32 v62, 0xffff0000, v63
    v_add_f32 v59, v59, v61
    v_add_f32 v60, v60, v62
    s_nop 0
    v_add_f32_dpp v59, v59, v59 row_shr:1 row_mask:0xf bank_mask:0xf bound_ctrl:0
    v_add_f32_dpp v60, v60, v60 row_shr:1 row_mask:0xf bank_mask:0xf bound_ctrl:0
    s_nop 0
    v_add_f32_dpp v59, v59, v59 row_shr:2 row_mask:0xf bank_mask:0xf bound_ctrl:0
    v_add_f32_dpp v60, v60, v60 row_shr:2 row_mask:0xf bank_mask:0xf bound_ctrl:0
    s_nop 0
    v_add_f32_dpp v59, v59, v59 row_shr:4 row_mask:0xf bank_mask:0xf bound_ctrl:0
    v_add_f32_dpp v60, v60, v60 row_shr:4 row_mask:0xf bank_mask:0xf bound_ctrl:0
    s_nop 0
    v_add_f32_dpp v59, v59, v59 row_shr:8 row_mask:0xf bank_mask:0xf bound_ctrl:0
    v_add_f32_dpp v60, v60, v60 row_shr:8 row_mask:0xf bank_mask:0xf bound_ctrl:0
    s_nop 0
    v_add_f32_dpp v59, v59, v59 row_bcast:15 row_mask:0xa bank_mask:0xf
    v_add_f32_dpp v60, v60, v60 row_bcast:15 row_mask:0xa bank_mask:0xf
    s_nop 0
    v_add_f32_dpp v59, v59, v59 row_bcast:31 row_mask:0xc bank_mask:0xf
    v_add_f32_dpp v60, v60, v60 row_bcast:31 row_mask:0xc bank_mask:0xf
    v_cvt_pk_bf16_f32 v63, v59, v60
    v_lshlrev_b32 v61, 16, v63
    v_and_b32 v62, 0xffff0000, v63
    v_mul_f32 v61, 0xbfb8aa3b, v61
    v_mul_f32 v62, 0xbfb8aa3b, v62
    v_exp_f32 v61, v61
    v_exp_f32 v62, v62
    v_add_f32 v61, 1.0, v61
    v_add_f32 v62, 1.0, v62
    v_rcp_f32 v61, v61
    v_rcp_f32 v62, v62
    s_nop 0
    v_cvt_pk_bf16_f32 v63, v61, v62
    v_lshlrev_b32 v52, 16, v63
    v_and_b32 v53, 0xffff0000, v63
    v_mov_b32 v61, 0
    s_lshl_b32 s31, s14, 2
    s_mov_b32 exec_lo, 0
    s_mov_b32 exec_hi, 0x80000000
    buffer_store_dwordx2 v[52:53], v61, s[32:35], s31 offen
    s_mov_b64 exec, -1
    v_add_f32 v52, v8, v44
    v_add_f32 v53, v9, v45
    v_sub_f32 v54, v8, v44
    v_sub_f32 v55, v9, v45
    v_add_f32 v8, v38, v46
    v_add_f32 v9, v39, v47
    v_sub_f32 v44, v38, v46
    v_sub_f32 v45, v39, v47
    v_add_f32 v38, v40, v48
    v_add_f32 v39, v41, v49
    v_sub_f32 v46, v40, v48
    v_sub_f32 v47, v41, v49
    v_add_f32 v40, v42, v50
    v_add_f32 v41, v43, v51
    v_sub_f32 v48, v42, v50
    v_sub_f32 v49, v43, v51
    v_add_f32 v42, v44, v45
    v_sub_f32 v43, v45, v44
    v_sub_f32 v50, v49, v48
    v_add_f32 v51, v49, v48
    v_add_f32 v44, v52, v38
    v_add_f32 v45, v53, v39
    v_sub_f32 v48, v52, v38
    v_sub_f32 v49, v53, v39
    v_add_f32 v56, v8, v40
    v_add_f32 v57, v9, v41
    v_sub_f32 v58, v8, v40
    v_sub_f32 v59, v9, v41
    v_add_f32 v8, v54, v47
    v_sub_f32 v9, v55, v46
    v_sub_f32 v38, v54, v47
    v_add_f32 v39, v55, v46
    v_add_f32 v40, v42, v50
    v_sub_f32 v41, v43, v51
    v_sub_f32 v46, v42, v50
    v_add_f32 v47, v43, v51
    v_add_f32 v42, v44, v56
    v_add_f32 v43, v45, v57
    v_sub_f32 v50, v44, v56
    v_sub_f32 v51, v45, v57
    v_add_f32 v52, v48, v59
    v_sub_f32 v53, v49, v58
    v_sub_f32 v54, v48, v59
    v_add_f32 v55, v49, v58
    v_fma_f32 v60, v40, s30, v8
    v_fma_f32 v61, v41, s30, v9
    v_fma_f32 v62, -v40, s30, v8
    v_fma_f32 v63, -v41, s30, v9
    v_fma_f32 v64, v47, s30, v38
    v_fma_f32 v65, -v46, s30, v39
    v_fma_f32 v66, -v47, s30, v38
    v_fma_f32 v67, v46, s30, v39
    ds_write_b64 v4, v[42:43] offset:0
    v_mul_f32_e64 v8, v60, v10
    v_mul_f32_e64 v9, v60, -v11
    v_fma_f32 v8, -v61, -v11, v8
    v_fma_f32 v9, v61, v10, v9
    ds_write_b64 v4, v[8:9] offset:576
    v_mul_f32_e64 v8, v52, v12
    v_mul_f32_e64 v9, v52, -v13
    v_fma_f32 v8, -v53, -v13, v8
    v_fma_f32 v9, v53, v12, v9
    ds_write_b64 v4, v[8:9] offset:1152
    v_mul_f32_e64 v8, v64, v14
    v_mul_f32_e64 v9, v64, -v15
    v_fma_f32 v8, -v65, -v15, v8
    v_fma_f32 v9, v65, v14, v9
    ds_write_b64 v4, v[8:9] offset:1728
    v_mul_f32_e64 v8, v50, v16
    v_mul_f32_e64 v9, v50, -v17
    v_fma_f32 v8, -v51, -v17, v8
    v_fma_f32 v9, v51, v16, v9
    ds_write_b64 v4, v[8:9] offset:2304
    v_mul_f32_e64 v8, v62, v18
    v_mul_f32_e64 v9, v62, -v19
    v_fma_f32 v8, -v63, -v19, v8
    v_fma_f32 v9, v63, v18, v9
    ds_write_b64 v4, v[8:9] offset:2880
    v_mul_f32_e64 v8, v54, v20
    v_mul_f32_e64 v9, v54, -v21
    v_fma_f32 v8, -v55, -v21, v8
    v_fma_f32 v9, v55, v20, v9
    ds_write_b64 v4, v[8:9] offset:3456
    v_mul_f32_e64 v8, v66, v22
    v_mul_f32_e64 v9, v66, -v23
    v_fma_f32 v8, -v67, -v23, v8
    v_fma_f32 v9, v67, v22, v9
    ds_write_b64 v4, v[8:9] offset:4032
    s_waitcnt vmcnt(25)
    s_barrier
    v_lshlrev_b32 v39, 1, v0
    v_add_u32 v39, 141312, v39
    ds_read_u16 v7, v39 offset:0
    ds_read_u16 v16, v39 offset:8192
    ds_read_u16 v8, v39 offset:1024
    ds_read_u16 v17, v39 offset:9216
    ds_read_u16 v9, v39 offset:2048
    ds_read_u16 v18, v39 offset:10240
    ds_read_u16 v10, v39 offset:3072
    ds_read_u16 v19, v39 offset:11264
    ds_read_u16 v11, v39 offset:4096
    ds_read_u16 v20, v39 offset:12288
    ds_read_u16 v12, v39 offset:5120
    ds_read_u16 v21, v39 offset:13312
    ds_read_u16 v13, v39 offset:6144
    ds_read_u16 v22, v39 offset:14336
    ds_read_u16 v14, v39 offset:7168
    ds_read_u16 v23, v39 offset:15360
    v_and_b32 v40, 7, v0
    v_lshlrev_b32 v40, 10, v40
    v_add_u32 v40, 141824, v40
    ds_read_u16 v15, v40
    ds_read_u16 v38, v40 offset:8192
    s_waitcnt lgkmcnt(0)
    v_lshl_or_b32 v16, v16, 16, v7
    v_lshl_or_b32 v17, v17, 16, v8
    v_lshl_or_b32 v18, v18, 16, v9
    v_lshl_or_b32 v19, v19, 16, v10
    v_lshl_or_b32 v20, v20, 16, v11
    v_lshl_or_b32 v21, v21, 16, v12
    v_lshl_or_b32 v22, v22, 16, v13
    v_lshl_or_b32 v23, v23, 16, v14
    v_lshl_or_b32 v15, v38, 16, v15
    s_movk_i32 s31, 8448
    v_mul_lo_u32 v40, v0, s31
    s_lshl_b32 s31, s2, 5
    buffer_store_dwordx4 v[16:19], v40, s[44:47], s31 offen
    buffer_store_dwordx4 v[20:23], v40, s[44:47], s31 offen offset:16
    v_cmp_gt_u32 vcc, 8, v0
    s_nop 0
    s_and_saveexec_b64 s[48:49], vcc
    s_cbranch_execz K1W256_4
    v_lshlrev_b32 v39, 2, v0
    s_add_u32 s31, s31, 0x210000
    buffer_store_dword v15, v39, s[44:47], s31 offen
K1W256_4:
    s_mov_b64 exec, -1
    s_waitcnt lgkmcnt(0)
    ds_read_b64 v[8:9], v5 offset:0
    ds_read_b64 v[10:11], v5 offset:64
    ds_read_b64 v[12:13], v5 offset:128
    ds_read_b64 v[14:15], v5 offset:192
    ds_read_b64 v[16:17], v5 offset:256
    ds_read_b64 v[18:19], v5 offset:320
    ds_read_b64 v[20:21], v5 offset:384
    ds_read_b64 v[22:23], v5 offset:448
    s_waitcnt lgkmcnt(0)
    v_add_f32 v38, v8, v16
    v_add_f32 v39, v9, v17
    v_sub_f32 v40, v8, v16
    v_sub_f32 v41, v9, v17
    v_add_f32 v8, v10, v18
    v_add_f32 v9, v11, v19
    v_sub_f32 v16, v10, v18
    v_sub_f32 v17, v11, v19
    v_add_f32 v10, v12, v20
    v_add_f32 v11, v13, v21
    v_sub_f32 v18, v12, v20
    v_sub_f32 v19, v13, v21
    v_add_f32 v12, v14, v22
    v_add_f32 v13, v15, v23
    v_sub_f32 v20, v14, v22
    v_sub_f32 v21, v15, v23
    v_add_f32 v14, v16, v17
    v_sub_f32 v15, v17, v16
    v_sub_f32 v22, v21, v20
    v_add_f32 v23, v21, v20
    v_add_f32 v16, v38, v10
    v_add_f32 v17, v39, v11
    v_sub_f32 v20, v38, v10
    v_sub_f32 v21, v39, v11
    v_add_f32 v42, v8, v12
    v_add_f32 v43, v9, v13
    v_sub_f32 v44, v8, v12
    v_sub_f32 v45, v9, v13
    v_add_f32 v8, v40, v19
    v_sub_f32 v9, v41, v18
    v_sub_f32 v10, v40, v19
    v_add_f32 v11, v41, v18
    v_add_f32 v12, v14, v22
    v_sub_f32 v13, v15, v23
    v_sub_f32 v18, v14, v22
    v_add_f32 v19, v15, v23
    v_add_f32 v14, v16, v42
    v_add_f32 v15, v17, v43
    v_sub_f32 v22, v16, v42
    v_sub_f32 v23, v17, v43
    v_add_f32 v38, v20, v45
    v_sub_f32 v39, v21, v44
    v_sub_f32 v40, v20, v45
    v_add_f32 v41, v21, v44
    v_fma_f32 v46, v12, s30, v8
    v_fma_f32 v47, v13, s30, v9
    v_fma_f32 v48, -v12, s30, v8
    v_fma_f32 v49, -v13, s30, v9
    v_fma_f32 v50, v19, s30, v10
    v_fma_f32 v51, -v18, s30, v11
    v_fma_f32 v52, -v19, s30, v10
    v_fma_f32 v53, v18, s30, v11
    ds_write_b64 v5, v[14:15] offset:0
    v_mul_f32_e64 v8, v46, v24
    v_mul_f32_e64 v9, v46, -v25
    v_fma_f32 v8, -v47, -v25, v8
    v_fma_f32 v9, v47, v24, v9
    ds_write_b64 v5, v[8:9] offset:72
    v_mul_f32_e64 v8, v38, v26
    v_mul_f32_e64 v9, v38, -v27
    v_fma_f32 v8, -v39, -v27, v8
    v_fma_f32 v9, v39, v26, v9
    ds_write_b64 v5, v[8:9] offset:144
    v_mul_f32_e64 v8, v50, v28
    v_mul_f32_e64 v9, v50, -v29
    v_fma_f32 v8, -v51, -v29, v8
    v_fma_f32 v9, v51, v28, v9
    ds_write_b64 v5, v[8:9] offset:216
    v_mul_f32_e64 v8, v22, v30
    v_mul_f32_e64 v9, v22, -v31
    v_fma_f32 v8, -v23, -v31, v8
    v_fma_f32 v9, v23, v30, v9
    ds_write_b64 v5, v[8:9] offset:288
    v_mul_f32_e64 v8, v48, v32
    v_mul_f32_e64 v9, v48, -v33
    v_fma_f32 v8, -v49, -v33, v8
    v_fma_f32 v9, v49, v32, v9
    ds_write_b64 v5, v[8:9] offset:360
    v_mul_f32_e64 v8, v40, v34
    v_mul_f32_e64 v9, v40, -v35
    v_fma_f32 v8, -v41, -v35, v8
    v_fma_f32 v9, v41, v34, v9
    ds_write_b64 v5, v[8:9] offset:432
    v_mul_f32_e64 v8, v52, v36
    v_mul_f32_e64 v9, v52, -v37
    v_fma_f32 v8, -v53, -v37, v8
    v_fma_f32 v9, v53, v36, v9
    ds_write_b64 v5, v[8:9] offset:504
    s_barrier
    s_waitcnt lgkmcnt(0)
    ds_read_b64 v[8:9], v6 offset:0
    ds_read_b64 v[10:11], v6 offset:8
    ds_read_b64 v[12:13], v6 offset:16
    ds_read_b64 v[14:15], v6 offset:24
    ds_read_b64 v[16:17], v6 offset:32
    ds_read_b64 v[18:19], v6 offset:40
    ds_read_b64 v[20:21], v6 offset:48
    ds_read_b64 v[22:23], v6 offset:56
    s_waitcnt lgkmcnt(0)
    v_add_f32 v24, v8, v16
    v_add_f32 v25, v9, v17
    v_sub_f32 v26, v8, v16
    v_sub_f32 v27, v9, v17
    v_add_f32 v8, v10, v18
    v_add_f32 v9, v11, v19
    v_sub_f32 v16, v10, v18
    v_sub_f32 v17, v11, v19
    v_add_f32 v10, v12, v20
    v_add_f32 v11, v13, v21
    v_sub_f32 v18, v12, v20
    v_sub_f32 v19, v13, v21
    v_add_f32 v12, v14, v22
    v_add_f32 v13, v15, v23
    v_sub_f32 v20, v14, v22
    v_sub_f32 v21, v15, v23
    v_add_f32 v14, v16, v17
    v_sub_f32 v15, v17, v16
    v_sub_f32 v22, v21, v20
    v_add_f32 v23, v21, v20
    v_add_f32 v16, v24, v10
    v_add_f32 v17, v25, v11
    v_sub_f32 v20, v24, v10
    v_sub_f32 v21, v25, v11
    v_add_f32 v28, v8, v12
    v_add_f32 v29, v9, v13
    v_sub_f32 v30, v8, v12
    v_sub_f32 v31, v9, v13
    v_add_f32 v8, v26, v19
    v_sub_f32 v9, v27, v18
    v_sub_f32 v10, v26, v19
    v_add_f32 v11, v27, v18
    v_add_f32 v12, v14, v22
    v_sub_f32 v13, v15, v23
    v_sub_f32 v18, v14, v22
    v_add_f32 v19, v15, v23
    v_add_f32 v14, v16, v28
    v_add_f32 v15, v17, v29
    v_sub_f32 v22, v16, v28
    v_sub_f32 v23, v17, v29
    v_add_f32 v24, v20, v31
    v_sub_f32 v25, v21, v30
    v_sub_f32 v26, v20, v31
    v_add_f32 v27, v21, v30
    v_fma_f32 v32, v12, s30, v8
    v_fma_f32 v33, v13, s30, v9
    v_fma_f32 v34, -v12, s30, v8
    v_fma_f32 v35, -v13, s30, v9
    v_fma_f32 v36, v19, s30, v10
    v_fma_f32 v37, -v18, s30, v11
    v_fma_f32 v38, -v19, s30, v10
    v_fma_f32 v39, v18, s30, v11
    v_lshrrev_b32 v4, 3, v1
    v_and_b32 v5, 7, v1
    v_lshl_add_u32 v4, v5, 3, v4
    v_mul_u32_u24 v5, 520, v2
    v_add_u32 v4, v4, v5
    v_lshlrev_b32 v4, 3, v4
    v_add_u32 v4, 122880, v4
    ds_write_b64 v4, v[14:15] offset:18432
    ds_write_b64 v4, v[32:33] offset:18944
    ds_write_b64 v4, v[24:25] offset:19456
    ds_write_b64 v4, v[36:37] offset:19968
    ds_write_b64 v4, v[22:23] offset:20480
    ds_write_b64 v4, v[34:35] offset:20992
    ds_write_b64 v4, v[26:27] offset:21504
    ds_write_b64 v4, v[38:39] offset:22016
    s_mov_b64 exec, 1
    ds_write_b64 v4, v[14:15] offset:22528
    s_mov_b64 exec, -1
    s_waitcnt lgkmcnt(0)
    s_barrier
    v_and_b32 v4, 3, v0
    v_lshrrev_b32 v5, 2, v0
    v_mul_u32_u24 v6, 520, v4
    v_sub_u32 v7, v6, v5
    v_add_u32 v6, v6, v5
    v_lshlrev_b32 v6, 3, v6
    v_add_u32 v7, 256, v7
    v_lshlrev_b32 v7, 3, v7
    v_add_u32 v6, 122880, v6
    v_add_u32 v7, 122880, v7
    v_mul_u32_u24 v8, 16640, v5
    v_lshl_add_u32 v8, v4, 4, v8
    s_lshl_b32 s29, s2, 6
    ds_read_b64 v[10:11], v6 offset:18432
    ds_read_b64 v[18:19], v7 offset:20480
    ds_read_b64 v[12:13], v6 offset:18944
    ds_read_b64 v[20:21], v7 offset:19968
    ds_read_b64 v[14:15], v6 offset:19456
    ds_read_b64 v[22:23], v7 offset:19456
    ds_read_b64 v[16:17], v6 offset:19968
    ds_read_b64 v[24:25], v7 offset:18944
    s_waitcnt lgkmcnt(6)
    v_add_f32 v28, v10, v18
    v_sub_f32 v29, v11, v19
    v_add_f32 v30, v11, v19
    v_sub_f32 v31, v18, v10
    s_add_u32 s31, s29, 0x0
    buffer_store_dwordx4 v[28:31], v8, s[24:27], s31 offen
    s_waitcnt lgkmcnt(4)
    v_add_f32 v32, v12, v20
    v_sub_f32 v33, v13, v21
    v_add_f32 v34, v13, v21
    v_sub_f32 v35, v20, v12
    s_add_u32 s31, s29, 0x104000
    buffer_store_dwordx4 v[32:35], v8, s[24:27], s31 offen
    s_waitcnt lgkmcnt(2)
    v_add_f32 v36, v14, v22
    v_sub_f32 v37, v15, v23
    v_add_f32 v38, v15, v23
    v_sub_f32 v39, v22, v14
    s_add_u32 s31, s29, 0x208000
    buffer_store_dwordx4 v[36:39], v8, s[24:27], s31 offen
    s_waitcnt lgkmcnt(0)
    v_add_f32 v40, v16, v24
    v_sub_f32 v41, v17, v25
    v_add_f32 v42, v17, v25
    v_sub_f32 v43, v24, v16
    s_add_u32 s31, s29, 0x30c000
    buffer_store_dwordx4 v[40:43], v8, s[24:27], s31 offen
    v_cmp_gt_u32 vcc, 4, v0
    s_waitcnt lgkmcnt(0)
    s_and_saveexec_b64 s[48:49], vcc
    s_cbranch_execz K1O256_5
    ds_read_b64 v[10:11], v6 offset:20480
    s_waitcnt lgkmcnt(0)
    v_add_f32 v44, v10, v10
    v_mov_b32 v45, 0
    v_add_f32 v46, v11, v11
    v_mov_b32 v47, 0
    s_add_u32 s31, s29, 0x410000
    buffer_store_dwordx4 v[44:47], v8, s[24:27], s31 offen
K1O256_5:
    s_mov_b64 exec, -1
    v_and_b32 v228, 63, v0
    v_bfe_u32 v226, v228, 2, 2
    v_lshrrev_b32 v229, 5, v228
    v_lshl_add_u32 v226, v229, 3, v226
    v_mul_u32_u24 v226, 1088, v226
    v_bfe_u32 v229, v228, 4, 1
    v_lshl_add_u32 v226, v229, 5, v226
    v_and_b32 v229, 3, v228
    v_lshl_add_u32 v226, v229, 3, v226
    s_lshl_b32 s96, s3, 8
    v_add_u32 v226, s96, v226
    v_lshlrev_b32 v227, 4, v228
    v_add_u32 v230, 52224, v225
    v_add_u32 v231, 52224, v226
    s_waitcnt vmcnt(27)
    ds_write_b128 v225, v[128:131] offset:0
    ds_write_b128 v225, v[132:135] offset:256
    ds_write_b128 v225, v[136:139] offset:512
    ds_write_b128 v225, v[140:143] offset:768
    s_waitcnt vmcnt(23)
    ds_write_b128 v225, v[144:147] offset:17408
    ds_write_b128 v225, v[148:151] offset:17664
    ds_write_b128 v225, v[152:155] offset:17920
    ds_write_b128 v225, v[156:159] offset:18176
    s_waitcnt vmcnt(19)
    ds_write_b128 v225, v[160:163] offset:34816
    ds_write_b128 v225, v[164:167] offset:35072
    ds_write_b128 v225, v[168:171] offset:35328
    ds_write_b128 v225, v[172:175] offset:35584
    s_waitcnt vmcnt(15)
    ds_write_b128 v230, v[176:179] offset:0
    ds_write_b128 v230, v[180:183] offset:256
    ds_write_b128 v230, v[184:187] offset:512
    ds_write_b128 v230, v[188:191] offset:768
    s_waitcnt vmcnt(11)
    ds_write_b128 v230, v[192:195] offset:17408
    ds_write_b128 v230, v[196:199] offset:17664
    ds_write_b128 v230, v[200:203] offset:17920
    ds_write_b128 v230, v[204:207] offset:18176
    s_waitcnt vmcnt(7)
    ds_write_b128 v230, v[208:211] offset:34816
    ds_write_b128 v230, v[212:215] offset:35072
    ds_write_b128 v230, v[216:219] offset:35328
    ds_write_b128 v230, v[220:223] offset:35584
    s_waitcnt lgkmcnt(0)
    s_barrier
    s_add_u32 s96, s58, 0
    s_mul_i32 s97, s3, 384
    s_add_u32 s97, s97, s96
    s_lshl_b32 s97, s97, 10
    ds_read_b64_tr_b16 v[128:129], v226 offset:0
    ds_read_b64_tr_b16 v[130:131], v226 offset:4352
    ds_read_b64_tr_b16 v[132:133], v226 offset:64
    ds_read_b64_tr_b16 v[134:135], v226 offset:4416
    ds_read_b64_tr_b16 v[136:137], v226 offset:128
    ds_read_b64_tr_b16 v[138:139], v226 offset:4480
    ds_read_b64_tr_b16 v[140:141], v226 offset:192
    ds_read_b64_tr_b16 v[142:143], v226 offset:4544
    s_waitcnt lgkmcnt(6)
    s_add_u32 s96, s97, 0
    buffer_store_dwordx4 v[128:131], v227, s[76:79], s96 offen
    s_waitcnt lgkmcnt(4)
    s_add_u32 s96, s97, 98304
    buffer_store_dwordx4 v[132:135], v227, s[76:79], s96 offen
    s_waitcnt lgkmcnt(2)
    s_add_u32 s96, s97, 196608
    buffer_store_dwordx4 v[136:139], v227, s[76:79], s96 offen
    s_waitcnt lgkmcnt(0)
    s_add_u32 s96, s97, 294912
    buffer_store_dwordx4 v[140:143], v227, s[76:79], s96 offen
    s_add_u32 s96, s58, 1
    s_mul_i32 s97, s3, 384
    s_add_u32 s97, s97, s96
    s_lshl_b32 s97, s97, 10
    ds_read_b64_tr_b16 v[144:145], v226 offset:17408
    ds_read_b64_tr_b16 v[146:147], v226 offset:21760
    ds_read_b64_tr_b16 v[148:149], v226 offset:17472
    ds_read_b64_tr_b16 v[150:151], v226 offset:21824
    ds_read_b64_tr_b16 v[152:153], v226 offset:17536
    ds_read_b64_tr_b16 v[154:155], v226 offset:21888
    ds_read_b64_tr_b16 v[156:157], v226 offset:17600
    ds_read_b64_tr_b16 v[158:159], v226 offset:21952
    s_waitcnt lgkmcnt(6)
    s_add_u32 s96, s97, 0
    buffer_store_dwordx4 v[144:147], v227, s[76:79], s96 offen
    s_waitcnt lgkmcnt(4)
    s_add_u32 s96, s97, 98304
    buffer_store_dwordx4 v[148:151], v227, s[76:79], s96 offen
    s_waitcnt lgkmcnt(2)
    s_add_u32 s96, s97, 196608
    buffer_store_dwordx4 v[152:155], v227, s[76:79], s96 offen
    s_waitcnt lgkmcnt(0)
    s_add_u32 s96, s97, 294912
    buffer_store_dwordx4 v[156:159], v227, s[76:79], s96 offen
    s_add_u32 s96, s58, 2
    s_mul_i32 s97, s3, 384
    s_add_u32 s97, s97, s96
    s_lshl_b32 s97, s97, 10
    ds_read_b64_tr_b16 v[160:161], v226 offset:34816
    ds_read_b64_tr_b16 v[162:163], v226 offset:39168
    ds_read_b64_tr_b16 v[164:165], v226 offset:34880
    ds_read_b64_tr_b16 v[166:167], v226 offset:39232
    ds_read_b64_tr_b16 v[168:169], v226 offset:34944
    ds_read_b64_tr_b16 v[170:171], v226 offset:39296
    ds_read_b64_tr_b16 v[172:173], v226 offset:35008
    ds_read_b64_tr_b16 v[174:175], v226 offset:39360
    s_waitcnt lgkmcnt(6)
    s_add_u32 s96, s97, 0
    buffer_store_dwordx4 v[160:163], v227, s[76:79], s96 offen
    s_waitcnt lgkmcnt(4)
    s_add_u32 s96, s97, 98304
    buffer_store_dwordx4 v[164:167], v227, s[76:79], s96 offen
    s_waitcnt lgkmcnt(2)
    s_add_u32 s96, s97, 196608
    buffer_store_dwordx4 v[168:171], v227, s[76:79], s96 offen
    s_waitcnt lgkmcnt(0)
    s_add_u32 s96, s97, 294912
    buffer_store_dwordx4 v[172:175], v227, s[76:79], s96 offen
    s_add_u32 s96, s58, 3
    s_mul_i32 s97, s3, 384
    s_add_u32 s97, s97, s96
    s_lshl_b32 s97, s97, 10
    ds_read_b64_tr_b16 v[176:177], v231 offset:0
    ds_read_b64_tr_b16 v[178:179], v231 offset:4352
    ds_read_b64_tr_b16 v[180:181], v231 offset:64
    ds_read_b64_tr_b16 v[182:183], v231 offset:4416
    ds_read_b64_tr_b16 v[184:185], v231 offset:128
    ds_read_b64_tr_b16 v[186:187], v231 offset:4480
    ds_read_b64_tr_b16 v[188:189], v231 offset:192
    ds_read_b64_tr_b16 v[190:191], v231 offset:4544
    s_waitcnt lgkmcnt(6)
    s_add_u32 s96, s97, 0
    buffer_store_dwordx4 v[176:179], v227, s[76:79], s96 offen
    s_waitcnt lgkmcnt(4)
    s_add_u32 s96, s97, 98304
    buffer_store_dwordx4 v[180:183], v227, s[76:79], s96 offen
    s_waitcnt lgkmcnt(2)
    s_add_u32 s96, s97, 196608
    buffer_store_dwordx4 v[184:187], v227, s[76:79], s96 offen
    s_waitcnt lgkmcnt(0)
    s_add_u32 s96, s97, 294912
    buffer_store_dwordx4 v[188:191], v227, s[76:79], s96 offen
    s_add_u32 s96, s58, 4
    s_mul_i32 s97, s3, 384
    s_add_u32 s97, s97, s96
    s_lshl_b32 s97, s97, 10
    ds_read_b64_tr_b16 v[192:193], v231 offset:17408
    ds_read_b64_tr_b16 v[194:195], v231 offset:21760
    ds_read_b64_tr_b16 v[196:197], v231 offset:17472
    ds_read_b64_tr_b16 v[198:199], v231 offset:21824
    ds_read_b64_tr_b16 v[200:201], v231 offset:17536
    ds_read_b64_tr_b16 v[202:203], v231 offset:21888
    ds_read_b64_tr_b16 v[204:205], v231 offset:17600
    ds_read_b64_tr_b16 v[206:207], v231 offset:21952
    s_waitcnt lgkmcnt(6)
    s_add_u32 s96, s97, 0
    buffer_store_dwordx4 v[192:195], v227, s[76:79], s96 offen
    s_waitcnt lgkmcnt(4)
    s_add_u32 s96, s97, 98304
    buffer_store_dwordx4 v[196:199], v227, s[76:79], s96 offen
    s_waitcnt lgkmcnt(2)
    s_add_u32 s96, s97, 196608
    buffer_store_dwordx4 v[200:203], v227, s[76:79], s96 offen
    s_waitcnt lgkmcnt(0)
    s_add_u32 s96, s97, 294912
    buffer_store_dwordx4 v[204:207], v227, s[76:79], s96 offen
    s_add_u32 s96, s58, 5
    s_mul_i32 s97, s3, 384
    s_add_u32 s97, s97, s96
    s_lshl_b32 s97, s97, 10
    ds_read_b64_tr_b16 v[208:209], v231 offset:34816
    ds_read_b64_tr_b16 v[210:211], v231 offset:39168
    ds_read_b64_tr_b16 v[212:213], v231 offset:34880
    ds_read_b64_tr_b16 v[214:215], v231 offset:39232
    ds_read_b64_tr_b16 v[216:217], v231 offset:34944
    ds_read_b64_tr_b16 v[218:219], v231 offset:39296
    ds_read_b64_tr_b16 v[220:221], v231 offset:35008
    ds_read_b64_tr_b16 v[222:223], v231 offset:39360
    s_waitcnt lgkmcnt(6)
    s_add_u32 s96, s97, 0
    buffer_store_dwordx4 v[208:211], v227, s[76:79], s96 offen
    s_waitcnt lgkmcnt(4)
    s_add_u32 s96, s97, 98304
    buffer_store_dwordx4 v[212:215], v227, s[76:79], s96 offen
    s_waitcnt lgkmcnt(2)
    s_add_u32 s96, s97, 196608
    buffer_store_dwordx4 v[216:219], v227, s[76:79], s96 offen
    s_waitcnt lgkmcnt(0)
    s_add_u32 s96, s97, 294912
    buffer_store_dwordx4 v[220:223], v227, s[76:79], s96 offen
PKEND_6:
    s_endpgm
K1_EXIT:
    s_endpgm
.globl k2_kernel
.p2align 8
.type k2_kernel,@function
k2_kernel:
    s_cmp_ge_u32 s2, 257
    s_cbranch_scc1 K2_EXIT
    s_load_dwordx2 s[12:13], s[0:1], 80
    s_mov_b32 s30, 0x3f3504f3
    v_lshrrev_b32 v1, 6, v0
    s_nop 0
    v_readfirstlane_b32 s3, v1
    s_waitcnt lgkmcnt(0)
    s_mov_b32 s24, s12
    s_mov_b32 s25, s13
    s_mov_b32 s26, 0x414100
    s_mov_b32 s27, 0x00020000
    s_add_u32 s44, s12, 0x480000
    s_addc_u32 s45, s13, 0
    s_mov_b32 s46, 0x212100
    s_mov_b32 s47, 0x00020000
    s_cmp_ge_u32 s2, 256
    s_cbranch_scc1 K2_FFTONLY
    s_add_u32 s16, s12, 0x700000
    s_addc_u32 s17, s13, 0
    s_mov_b32 s18, 0x560000
    s_mov_b32 s19, 0x00020000
    s_add_u32 s20, s12, 0x1000000
    s_addc_u32 s21, s13, 0
    s_mov_b32 s22, 0x180000
    s_mov_b32 s23, 0x00020000
    s_add_u32 s32, s12, 0xd00000
    s_addc_u32 s33, s13, 0
    s_mov_b32 s34, 0x200000
    s_mov_b32 s35, 0x00020000
    s_and_b32 s56, s2, 7
    s_lshl_b32 s56, s56, 2
    s_bfe_u32 s96, s2, 0x20003
    s_add_u32 s56, s56, s96
    s_lshr_b32 s57, s2, 5
    s_mul_i32 s60, s56, 176128
    s_lshl_b32 s96, s3, 12
    s_add_u32 s60, s60, s96
    s_mul_i32 s61, s57, 196608
    s_lshl_b32 s96, s3, 12
    s_add_u32 s61, s61, s96
    v_and_b32 v1, 63, v0
    v_lshlrev_b32 v95, 4, v1
    s_mul_i32 s14, s2, 16640
    s_mul_i32 s15, s2, 8448
    v_lshlrev_b32 v1, 3, v0
    v_lshlrev_b32 v2, 5, v0
    s_add_u32 s31, s14, 0
    buffer_load_dwordx2 v[4:5], v1, s[24:27], s31 offen
    s_add_u32 s31, s14, 2048
    buffer_load_dwordx2 v[6:7], v1, s[24:27], s31 offen
    s_add_u32 s31, s14, 4096
    buffer_load_dwordx2 v[8:9], v1, s[24:27], s31 offen
    s_add_u32 s31, s14, 6144
    buffer_load_dwordx2 v[10:11], v1, s[24:27], s31 offen
    s_add_u32 s31, s14, 8192
    buffer_load_dwordx2 v[12:13], v1, s[24:27], s31 offen
    s_add_u32 s31, s14, 10240
    buffer_load_dwordx2 v[14:15], v1, s[24:27], s31 offen
    s_add_u32 s31, s14, 12288
    buffer_load_dwordx2 v[16:17], v1, s[24:27], s31 offen
    s_add_u32 s31, s14, 14336
    buffer_load_dwordx2 v[18:19], v1, s[24:27], s31 offen
    buffer_load_dwordx4 v[20:23], v2, s[44:47], s15 offen
    buffer_load_dwordx4 v[24:27], v2, s[44:47], s15 offen offset:16
    s_add_u32 s96, s60, 0
    buffer_load_dwordx4 v[96:99], v95, s[16:19], s96 offen offset:0
    buffer_load_dwordx4 v[104:107], v95, s[16:19], s96 offen offset:1024
    s_add_u32 s96, s60, 88064
    buffer_load_dwordx4 v[100:103], v95, s[16:19], s96 offen offset:0
    buffer_load_dwordx4 v[108:111], v95, s[16:19], s96 offen offset:1024
    s_add_u32 s96, s61, 0
    buffer_load_dwordx4 v[112:115], v95, s[20:23], s96 offen offset:0
    buffer_load_dwordx4 v[120:123], v95, s[20:23], s96 offen offset:1024
    s_add_u32 s96, s61, 98304
    buffer_load_dwordx4 v[116:119], v95, s[20:23], s96 offen offset:0
    buffer_load_dwordx4 v[124:127], v95, s[20:23], s96 offen offset:1024
    s_add_u32 s96, s60, 0
    buffer_load_dwordx4 v[128:131], v95, s[16:19], s96 offen offset:2048
    buffer_load_dwordx4 v[136:139], v95, s[16:19], s96 offen offset:3072
    s_add_u32 s96, s60, 88064
    buffer_load_dwordx4 v[132:135], v95, s[16:19], s96 offen offset:2048
    buffer_load_dwordx4 v[140:143], v95, s[16:19], s96 offen offset:3072
    s_add_u32 s96, s61, 0
    buffer_load_dwordx4 v[144:147], v95, s[20:23], s96 offen offset:2048
    buffer_load_dwordx4 v[152:155], v95, s[20:23], s96 offen offset:3072
    s_add_u32 s96, s61, 98304
    buffer_load_dwordx4 v[148:151], v95, s[20:23], s96 offen offset:2048
    buffer_load_dwordx4 v[156:159], v95, s[20:23], s96 offen offset:3072
    s_add_u32 s96, s60, 16384
    buffer_load_dwordx4 v[160:163], v95, s[16:19], s96 offen offset:0
    buffer_load_dwordx4 v[168:171], v95, s[16:19], s96 offen offset:1024
    s_add_u32 s96, s60, 104448
    buffer_load_dwordx4 v[164:167], v95, s[16:19], s96 offen offset:0
    buffer_load_dwordx4 v[172:175], v95, s[16:19], s96 offen offset:1024
    s_add_u32 s96, s61, 16384
    buffer_load_dwordx4 v[176:179], v95, s[20:23], s96 offen offset:0
    buffer_load_dwordx4 v[184:187], v95, s[20:23], s96 offen offset:1024
    s_add_u32 s96, s61, 114688
    buffer_load_dwordx4 v[180:183], v95, s[20:23], s96 offen offset:0
    buffer_load_dwordx4 v[188:191], v95, s[20:23], s96 offen offset:1024
    v_mov_b32 v192, 0
    v_mov_b32 v193, 0
    v_mov_b32 v194, 0
    v_mov_b32 v195, 0
    v_mov_b32 v196, 0
    v_mov_b32 v197, 0
    v_mov_b32 v198, 0
    v_mov_b32 v199, 0
    v_mov_b32 v200, 0
    v_mov_b32 v201, 0
    v_mov_b32 v202, 0
    v_mov_b32 v203, 0
    v_mov_b32 v204, 0
    v_mov_b32 v205, 0
    v_mov_b32 v206, 0
    v_mov_b32 v207, 0
    v_mov_b32 v208, 0
    v_mov_b32 v209, 0
    v_mov_b32 v210, 0
    v_mov_b32 v211, 0
    v_mov_b32 v212, 0
    v_mov_b32 v213, 0
    v_mov_b32 v214, 0
    v_mov_b32 v215, 0
    v_mov_b32 v216, 0
    v_mov_b32 v217, 0
    v_mov_b32 v218, 0
    v_mov_b32 v219, 0
    v_mov_b32 v220, 0
    v_mov_b32 v221, 0
    v_mov_b32 v222, 0
    v_mov_b32 v223, 0
    v_mov_b32 v224, 0
    v_mov_b32 v225, 0
    v_mov_b32 v226, 0
    v_mov_b32 v227, 0
    v_mov_b32 v228, 0
    v_mov_b32 v229, 0
    v_mov_b32 v230, 0
    v_mov_b32 v231, 0
    v_mov_b32 v232, 0
    v_mov_b32 v233, 0
    v_mov_b32 v234, 0
    v_mov_b32 v235, 0
    v_mov_b32 v236, 0
    v_mov_b32 v237, 0
    v_mov_b32 v238, 0
    v_mov_b32 v239, 0
    v_mov_b32 v240, 0
    v_mov_b32 v241, 0
    v_mov_b32 v242, 0
    v_mov_b32 v243, 0
    v_mov_b32 v244, 0
    v_mov_b32 v245, 0
    v_mov_b32 v246, 0
    v_mov_b32 v247, 0
    v_mov_b32 v248, 0
    v_mov_b32 v249, 0
    v_mov_b32 v250, 0
    v_mov_b32 v251, 0
    v_mov_b32 v252, 0
    v_mov_b32 v253, 0
    v_mov_b32 v254, 0
    v_mov_b32 v255, 0
    v_and_b32 v33, 31, v0
    v_and_b32 v34, 3, v0
    v_lshrrev_b32 v2, 5, v0
    v_lshl_add_u32 v29, v2, 8, v33
    v_lshlrev_b32 v29, 3, v29
    v_mul_u32_u24 v3, 288, v2
    v_add_u32 v30, v3, v33
    v_lshlrev_b32 v30, 3, v30
    v_bfe_u32 v28, v0, 2, 3
    v_mul_u32_u24 v28, 36, v28
    v_add_u32 v3, v3, v28
    v_add_u32 v31, v3, v34
    v_lshlrev_b32 v31, 3, v31
    v_mul_u32_u24 v28, 9, v34
    v_add_u32 v32, v3, v28
    v_lshlrev_b32 v32, 3, v32
    v_cvt_f32_u32 v2, v0
    v_mul_f32 v28, 0x3a000000, v2
    v_fract_f32 v28, v28
    v_cos_f32 v3, v28
    v_sin_f32 v28, v28
    v_mul_f32 v36, 0x3a800000, v2
    v_fract_f32 v36, v36
    v_cos_f32 v35, v36
    v_sin_f32 v36, v36
    v_mul_f32 v38, 0x3ac00000, v2
    v_fract_f32 v38, v38
    v_cos_f32 v37, v38
    v_sin_f32 v38, v38
    v_mul_f32 v40, 0x3b000000, v2
    v_fract_f32 v40, v40
    v_cos_f32 v39, v40
    v_sin_f32 v40, v40
    v_mul_f32 v42, 0x3b200000, v2
    v_fract_f32 v42, v42
    v_cos_f32 v41, v42
    v_sin_f32 v42, v42
    v_mul_f32 v44, 0x3b400000, v2
    v_fract_f32 v44, v44
    v_cos_f32 v43, v44
    v_sin_f32 v44, v44
    v_mul_f32 v46, 0x3b600000, v2
    v_fract_f32 v46, v46
    v_cos_f32 v45, v46
    v_sin_f32 v46, v46
    v_cvt_f32_u32 v2, v33
    v_mul_f32 v48, 0x3b800000, v2
    v_fract_f32 v48, v48
    v_cos_f32 v47, v48
    v_sin_f32 v48, v48
    v_mul_f32 v50, 0x3c000000, v2
    v_fract_f32 v50, v50
    v_cos_f32 v49, v50
    v_sin_f32 v50, v50
    v_mul_f32 v52, 0x3c400000, v2
    v_fract_f32 v52, v52
    v_cos_f32 v51, v52
    v_sin_f32 v52, v52
    v_mul_f32 v54, 0x3c800000, v2
    v_fract_f32 v54, v54
    v_cos_f32 v53, v54
    v_sin_f32 v54, v54
    v_mul_f32 v56, 0x3ca00000, v2
    v_fract_f32 v56, v56
    v_cos_f32 v55, v56
    v_sin_f32 v56, v56
    v_mul_f32 v58, 0x3cc00000, v2
    v_fract_f32 v58, v58
    v_cos_f32 v57, v58
    v_sin_f32 v58, v58
    v_mul_f32 v60, 0x3ce00000, v2
    v_fract_f32 v60, v60
    v_cos_f32 v59, v60
    v_sin_f32 v60, v60
    v_cvt_f32_u32 v2, v34
    v_mul_f32 v62, 0x3d000000, v2
    v_fract_f32 v62, v62
    v_cos_f32 v61, v62
    v_sin_f32 v62, v62
    v_mul_f32 v64, 0x3d800000, v2
    v_fract_f32 v64, v64
    v_cos_f32 v63, v64
    v_sin_f32 v64, v64
    v_mul_f32 v66, 0x3dc00000, v2
    v_fract_f32 v66, v66
    v_cos_f32 v65, v66
    v_sin_f32 v66, v66
    v_mul_f32 v68, 0x3e000000, v2
    v_fract_f32 v68, v68
    v_cos_f32 v67, v68
    v_sin_f32 v68, v68
    v_mul_f32 v70, 0x3e200000, v2
    v_fract_f32 v70, v70
    v_cos_f32 v69, v70
    v_sin_f32 v70, v70
    v_mul_f32 v72, 0x3e400000, v2
    v_fract_f32 v72, v72
    v_cos_f32 v71, v72
    v_sin_f32 v72, v72
    v_mul_f32 v74, 0x3e600000, v2
    v_fract_f32 v74, v74
    v_cos_f32 v73, v74
    v_sin_f32 v74, v74
    s_waitcnt vmcnt(26)
    v_add_f32 v76, v4, v12
    v_add_f32 v77, v5, v13
    v_sub_f32 v78, v4, v12
    v_sub_f32 v79, v5, v13
    v_add_f32 v4, v6, v14
    v_add_f32 v5, v7, v15
    v_sub_f32 v12, v6, v14
    v_sub_f32 v13, v7, v15
    v_add_f32 v6, v8, v16
    v_add_f32 v7, v9, v17
    v_sub_f32 v14, v8, v16
    v_sub_f32 v15, v9, v17
    v_add_f32 v8, v10, v18
    v_add_f32 v9, v11, v19
    v_sub_f32 v16, v10, v18
    v_sub_f32 v17, v11, v19
    v_add_f32 v10, v12, v13
    v_sub_f32 v11, v13, v12
    v_sub_f32 v18, v17, v16
    v_add_f32 v19, v17, v16
    v_add_f32 v12, v76, v6
    v_add_f32 v13, v77, v7
    v_sub_f32 v16, v76, v6
    v_sub_f32 v17, v77, v7
    v_add_f32 v80, v4, v8
    v_add_f32 v81, v5, v9
    v_sub_f32 v82, v4, v8
    v_sub_f32 v83, v5, v9
    v_add_f32 v4, v78, v15
    v_sub_f32 v5, v79, v14
    v_sub_f32 v6, v78, v15
    v_add_f32 v7, v79, v14
    v_add_f32 v8, v10, v18
    v_sub_f32 v9, v11, v19
    v_sub_f32 v14, v10, v18
    v_add_f32 v15, v11, v19
    v_add_f32 v10, v12, v80
    v_add_f32 v11, v13, v81
    v_sub_f32 v18, v12, v80
    v_sub_f32 v19, v13, v81
    v_add_f32 v76, v16, v83
    s_waitcnt vmcnt(16)
    v_mfma_f32_32x32x16_bf16 v[192:207], v[112:115], v[96:99], v[192:207]
    v_sub_f32 v77, v17, v82
    v_sub_f32 v78, v16, v83
    v_add_f32 v79, v17, v82
    v_fma_f32 v84, v8, s30, v4
    v_fma_f32 v85, v9, s30, v5
    v_fma_f32 v86, -v8, s30, v4
    v_mfma_f32_32x32x16_bf16 v[224:239], v[116:119], v[96:99], v[224:239]
    v_fma_f32 v87, -v9, s30, v5
    v_fma_f32 v88, v15, s30, v6
    v_fma_f32 v89, -v14, s30, v7
    v_fma_f32 v90, -v15, s30, v6
    v_fma_f32 v91, v14, s30, v7
    v_mul_f32_e64 v4, v84, v3
    v_mfma_f32_32x32x16_bf16 v[208:223], v[112:115], v[100:103], v[208:223]
    v_mul_f32_e64 v5, v84, -v28
    v_fma_f32 v4, -v85, -v28, v4
    v_fma_f32 v5, v85, v3, v5
    v_mul_f32_e64 v6, v76, v35
    v_mul_f32_e64 v7, v76, -v36
    v_fma_f32 v6, -v77, -v36, v6
    v_mfma_f32_32x32x16_bf16 v[240:255], v[116:119], v[100:103], v[240:255]
    v_fma_f32 v7, v77, v35, v7
    v_mul_f32_e64 v8, v88, v37
    v_mul_f32_e64 v9, v88, -v38
    v_fma_f32 v8, -v89, -v38, v8
    v_fma_f32 v9, v89, v37, v9
    v_mul_f32_e64 v12, v18, v39
    v_mfma_f32_32x32x16_bf16 v[192:207], v[120:123], v[104:107], v[192:207]
    v_mul_f32_e64 v13, v18, -v40
    v_fma_f32 v12, -v19, -v40, v12
    v_fma_f32 v13, v19, v39, v13
    v_mul_f32_e64 v14, v86, v41
    v_mul_f32_e64 v15, v86, -v42
    v_fma_f32 v14, -v87, -v42, v14
    v_mfma_f32_32x32x16_bf16 v[224:239], v[124:127], v[104:107], v[224:239]
    v_fma_f32 v15, v87, v41, v15
    v_mul_f32_e64 v16, v78, v43
    v_mul_f32_e64 v17, v78, -v44
    v_fma_f32 v16, -v79, -v44, v16
    v_fma_f32 v17, v79, v43, v17
    v_mul_f32_e64 v18, v90, v45
    v_mfma_f32_32x32x16_bf16 v[208:223], v[120:123], v[108:111], v[208:223]
    v_mul_f32_e64 v19, v90, -v46
    v_fma_f32 v18, -v91, -v46, v18
    v_fma_f32 v19, v91, v45, v19
    ds_write_b64 v1, v[10:11] offset:0
    ds_write_b64 v1, v[4:5] offset:2048
    ds_write_b64 v1, v[6:7] offset:4096
    v_mfma_f32_32x32x16_bf16 v[240:255], v[124:127], v[108:111], v[240:255]
    ds_write_b64 v1, v[8:9] offset:6144
    ds_write_b64 v1, v[12:13] offset:8192
    ds_write_b64 v1, v[14:15] offset:10240
    ds_write_b64 v1, v[16:17] offset:12288
    ds_write_b64 v1, v[18:19] offset:14336
    s_waitcnt lgkmcnt(0)
    s_add_u32 s96, s60, 16384
    buffer_load_dwordx4 v[96:99], v95, s[16:19], s96 offen offset:2048
    buffer_load_dwordx4 v[104:107], v95, s[16:19], s96 offen offset:3072
    s_add_u32 s96, s60, 104448
    buffer_load_dwordx4 v[100:103], v95, s[16:19], s96 offen offset:2048
    buffer_load_dwordx4 v[108:111], v95, s[16:19], s96 offen offset:3072
    s_add_u32 s96, s61, 16384
    buffer_load_dwordx4 v[112:115], v95, s[20:23], s96 offen offset:2048
    buffer_load_dwordx4 v[120:123], v95, s[20:23], s96 offen offset:3072
    s_add_u32 s96, s61, 114688
    buffer_load_dwordx4 v[116:119], v95, s[20:23], s96 offen offset:2048
    buffer_load_dwordx4 v[124:127], v95, s[20:23], s96 offen offset:3072
    s_waitcnt vmcnt(16)
    v_mfma_f32_32x32x16_bf16 v[192:207], v[144:147], v[128:131], v[192:207]
    s_barrier
    ds_read_b64 v[4:5], v29 offset:0
    ds_read_b64 v[6:7], v29 offset:256
    ds_read_b64 v[8:9], v29 offset:512
    ds_read_b64 v[10:11], v29 offset:768
    ds_read_b64 v[12:13], v29 offset:1024
    v_mfma_f32_32x32x16_bf16 v[224:239], v[148:151], v[128:131], v[224:239]
    ds_read_b64 v[14:15], v29 offset:1280
    ds_read_b64 v[16:17], v29 offset:1536
    ds_read_b64 v[18:19], v29 offset:1792
    s_waitcnt lgkmcnt(0)
    v_add_f32 v76, v4, v12
    v_add_f32 v77, v5, v13
    v_mfma_f32_32x32x16_bf16 v[208:223], v[144:147], v[132:135], v[208:223]
    v_sub_f32 v78, v4, v12
    v_sub_f32 v79, v5, v13
    v_add_f32 v4, v6, v14
    v_add_f32 v5, v7, v15
    v_sub_f32 v12, v6, v14
    v_sub_f32 v13, v7, v15
    v_mfma_f32_32x32x16_bf16 v[240:255], v[148:151], v[132:135], v[240:255]
    v_add_f32 v6, v8, v16
    v_add_f32 v7, v9, v17
    v_sub_f32 v14, v8, v16
    v_sub_f32 v15, v9, v17
    v_add_f32 v8, v10, v18
    v_add_f32 v9, v11, v19
    v_mfma_f32_32x32x16_bf16 v[192:207], v[152:155], v[136:139], v[192:207]
    v_sub_f32 v16, v10, v18
    v_sub_f32 v17, v11, v19
    v_add_f32 v10, v12, v13
    v_sub_f32 v11, v13, v12
    v_sub_f32 v18, v17, v16
    v_add_f32 v19, v17, v16
    v_mfma_f32_32x32x16_bf16 v[224:239], v[156:159], v[136:139], v[224:239]
    v_add_f32 v12, v76, v6
    v_add_f32 v13, v77, v7
    v_sub_f32 v16, v76, v6
    v_sub_f32 v17, v77, v7
    v_add_f32 v80, v4, v8
    v_add_f32 v81, v5, v9
    v_mfma_f32_32x32x16_bf16 v[208:223], v[152:155], v[140:143], v[208:223]
    v_sub_f32 v82, v4, v8
    v_sub_f32 v83, v5, v9
    v_add_f32 v4, v78, v15
    v_sub_f32 v5, v79, v14
    v_sub_f32 v6, v78, v15
    v_add_f32 v7, v79, v14
    v_mfma_f32_32x32x16_bf16 v[240:255], v[156:159], v[140:143], v[240:255]
    v_add_f32 v8, v10, v18
    v_sub_f32 v9, v11, v19
    v_sub_f32 v14, v10, v18
    v_add_f32 v15, v11, v19
    v_add_f32 v10, v12, v80
    v_add_f32 v11, v13, v81
    s_add_u32 s96, s60, 32768
    buffer_load_dwordx4 v[128:131], v95, s[16:19], s96 offen offset:0
    buffer_load_dwordx4 v[136:139], v95, s[16:19], s96 offen offset:1024
    s_add_u32 s96, s60, 120832
    buffer_load_dwordx4 v[132:135], v95, s[16:19], s96 offen offset:0
    buffer_load_dwordx4 v[140:143], v95, s[16:19], s96 offen offset:1024
    s_add_u32 s96, s61, 32768
    buffer_load_dwordx4 v[144:147], v95, s[20:23], s96 offen offset:0
    buffer_load_dwordx4 v[152:155], v95, s[20:23], s96 offen offset:1024
    s_add_u32 s96, s61, 131072
    buffer_load_dwordx4 v[148:151], v95, s[20:23], s96 offen offset:0
    buffer_load_dwordx4 v[156:159], v95, s[20:23], s96 offen offset:1024
    s_waitcnt vmcnt(16)
    v_mfma_f32_32x32x16_bf16 v[192:207], v[176:179], v[160:163], v[192:207]
    v_sub_f32 v18, v12, v80
    v_sub_f32 v19, v13, v81
    v_add_f32 v76, v16, v83
    v_sub_f32 v77, v17, v82
    v_sub_f32 v78, v16, v83
    v_add_f32 v79, v17, v82
    v_mfma_f32_32x32x16_bf16 v[224:239], v[180:183], v[160:163], v[224:239]
    v_fma_f32 v84, v8, s30, v4
    v_fma_f32 v85, v9, s30, v5
    v_fma_f32 v86, -v8, s30, v4
    v_fma_f32 v87, -v9, s30, v5
    v_fma_f32 v88, v15, s30, v6
    v_fma_f32 v89, -v14, s30, v7
    v_mfma_f32_32x32x16_bf16 v[208:223], v[176:179], v[164:167], v[208:223]
    v_fma_f32 v90, -v15, s30, v6
    v_fma_f32 v91, v14, s30, v7
    v_mul_f32_e64 v4, v84, v47
    v_mul_f32_e64 v5, v84, -v48
    v_fma_f32 v4, -v85, -v48, v4
    v_fma_f32 v5, v85, v47, v5
    v_mfma_f32_32x32x16_bf16 v[240:255], v[180:183], v[164:167], v[240:255]
    v_mul_f32_e64 v6, v76, v49
    v_mul_f32_e64 v7, v76, -v50
    v_fma_f32 v6, -v77, -v50, v6
    v_fma_f32 v7, v77, v49, v7
    v_mul_f32_e64 v8, v88, v51
    v_mul_f32_e64 v9, v88, -v52
    v_mfma_f32_32x32x16_bf16 v[192:207], v[184:187], v[168:171], v[192:207]
    v_fma_f32 v8, -v89, -v52, v8
    v_fma_f32 v9, v89, v51, v9
    v_mul_f32_e64 v12, v18, v53
    v_mul_f32_e64 v13, v18, -v54
    v_fma_f32 v12, -v19, -v54, v12
    v_fma_f32 v13, v19, v53, v13
    v_mfma_f32_32x32x16_bf16 v[224:239], v[188:191], v[168:171], v[224:239]
    v_mul_f32_e64 v14, v86, v55
    v_mul_f32_e64 v15, v86, -v56
    v_fma_f32 v14, -v87, -v56, v14
    v_fma_f32 v15, v87, v55, v15
    v_mul_f32_e64 v16, v78, v57
    v_mul_f32_e64 v17, v78, -v58
    v_mfma_f32_32x32x16_bf16 v[208:223], v[184:187], v[172:175], v[208:223]
    v_fma_f32 v16, -v79, -v58, v16
    v_fma_f32 v17, v79, v57, v17
    v_mul_f32_e64 v18, v90, v59
    v_mul_f32_e64 v19, v90, -v60
    v_fma_f32 v18, -v91, -v60, v18
    v_fma_f32 v19, v91, v59, v19
    v_mfma_f32_32x32x16_bf16 v[240:255], v[188:191], v[172:175], v[240:255]
    ds_write_b64 v30, v[10:11] offset:16384
    ds_write_b64 v30, v[4:5] offset:16672
    ds_write_b64 v30, v[6:7] offset:16960
    ds_write_b64 v30, v[8:9] offset:17248
    ds_write_b64 v30, v[12:13] offset:17536
    ds_write_b64 v30, v[14:15] offset:17824
    s_add_u32 s96, s60, 32768
    buffer_load_dwordx4 v[160:163], v95, s[16:19], s96 offen offset:2048
    buffer_load_dwordx4 v[168:171], v95, s[16:19], s96 offen offset:3072
    s_add_u32 s96, s60, 120832
    buffer_load_dwordx4 v[164:167], v95, s[16:19], s96 offen offset:2048
    buffer_load_dwordx4 v[172:175], v95, s[16:19], s96 offen offset:3072
    s_add_u32 s96, s61, 32768
    buffer_load_dwordx4 v[176:179], v95, s[20:23], s96 offen offset:2048
    buffer_load_dwordx4 v[184:187], v95, s[20:23], s96 offen offset:3072
    s_add_u32 s96, s61, 131072
    buffer_load_dwordx4 v[180:183], v95, s[20:23], s96 offen offset:2048
    buffer_load_dwordx4 v[188:191], v95, s[20:23], s96 offen offset:3072
    s_waitcnt vmcnt(16)
    v_mfma_f32_32x32x16_bf16 v[192:207], v[112:115], v[96:99], v[192:207]
    ds_write_b64 v30, v[16:17] offset:18112
    ds_write_b64 v30, v[18:19] offset:18400
    s_waitcnt lgkmcnt(0)
    ds_read_b64 v[4:5], v31 offset:16384
    ds_read_b64 v[6:7], v31 offset:16416
    ds_read_b64 v[8:9], v31 offset:16448
    v_mfma_f32_32x32x16_bf16 v[224:239], v[116:119], v[96:99], v[224:239]
    ds_read_b64 v[10:11], v31 offset:16480
    ds_read_b64 v[12:13], v31 offset:16512
    ds_read_b64 v[14:15], v31 offset:16544
    ds_read_b64 v[16:17], v31 offset:16576
    ds_read_b64 v[18:19], v31 offset:16608
    s_waitcnt lgkmcnt(0)
    v_mfma_f32_32x32x16_bf16 v[208:223], v[112:115], v[100:103], v[208:223]
    v_add_f32 v76, v4, v12
    v_add_f32 v77, v5, v13
    v_sub_f32 v78, v4, v12
    v_sub_f32 v79, v5, v13
    v_add_f32 v4, v6, v14
    v_add_f32 v5, v7, v15
    v_mfma_f32_32x32x16_bf16 v[240:255], v[116:119], v[100:103], v[240:255]
    v_sub_f32 v12, v6, v14
    v_sub_f32 v13, v7, v15
    v_add_f32 v6, v8, v16
    v_add_f32 v7, v9, v17
    v_sub_f32 v14, v8, v16
    v_sub_f32 v15, v9, v17
    v_mfma_f32_32x32x16_bf16 v[192:207], v[120:123], v[104:107], v[192:207]
    v_add_f32 v8, v10, v18
    v_add_f32 v9, v11, v19
    v_sub_f32 v16, v10, v18
    v_sub_f32 v17, v11, v19
    v_add_f32 v10, v12, v13
    v_sub_f32 v11, v13, v12
    v_mfma_f32_32x32x16_bf16 v[224:239], v[124:127], v[104:107], v[224:239]
    v_sub_f32 v18, v17, v16
    v_add_f32 v19, v17, v16
    v_add_f32 v12, v76, v6
    v_add_f32 v13, v77, v7
    v_sub_f32 v16, v76, v6
    v_sub_f32 v17, v77, v7
    v_mfma_f32_32x32x16_bf16 v[208:223], v[120:123], v[108:111], v[208:223]
    v_add_f32 v80, v4, v8
    v_add_f32 v81, v5, v9
    v_sub_f32 v82, v4, v8
    v_sub_f32 v83, v5, v9
    v_add_f32 v4, v78, v15
    v_sub_f32 v5, v79, v14
    v_mfma_f32_32x32x16_bf16 v[240:255], v[124:127], v[108:111], v[240:255]
    v_sub_f32 v6, v78, v15
    v_add_f32 v7, v79, v14
    v_add_f32 v8, v10, v18
    v_sub_f32 v9, v11, v19
    v_sub_f32 v14, v10, v18
    v_add_f32 v15, v11, v19
    s_add_u32 s96, s60, 49152
    buffer_load_dwordx4 v[96:99], v95, s[16:19], s96 offen offset:0
    buffer_load_dwordx4 v[104:107], v95, s[16:19], s96 offen offset:1024
    s_add_u32 s96, s60, 137216
    buffer_load_dwordx4 v[100:103], v95, s[16:19], s96 offen offset:0
    buffer_load_dwordx4 v[108:111], v95, s[16:19], s96 offen offset:1024
    s_add_u32 s96, s61, 49152
    buffer_load_dwordx4 v[112:115], v95, s[20:23], s96 offen offset:0
    buffer_load_dwordx4 v[120:123], v95, s[20:23], s96 offen offset:1024
    s_add_u32 s96, s61, 147456
    buffer_load_dwordx4 v[116:119], v95, s[20:23], s96 offen offset:0
    buffer_load_dwordx4 v[124:127], v95, s[20:23], s96 offen offset:1024
    s_waitcnt vmcnt(16)
    v_mfma_f32_32x32x16_bf16 v[192:207], v[144:147], v[128:131], v[192:207]
    v_add_f32 v10, v12, v80
    v_add_f32 v11, v13, v81
    v_sub_f32 v18, v12, v80
    v_sub_f32 v19, v13, v81
    v_add_f32 v76, v16, v83
    v_sub_f32 v77, v17, v82
    v_mfma_f32_32x32x16_bf16 v[224:239], v[148:151], v[128:131], v[224:239]
    v_sub_f32 v78, v16, v83
    v_add_f32 v79, v17, v82
    v_fma_f32 v84, v8, s30, v4
    v_fma_f32 v85, v9, s30, v5
    v_fma_f32 v86, -v8, s30, v4
    v_fma_f32 v87, -v9, s30, v5
    v_mfma_f32_32x32x16_bf16 v[208:223], v[144:147], v[132:135], v[208:223]
    v_fma_f32 v88, v15, s30, v6
    v_fma_f32 v89, -v14, s30, v7
    v_fma_f32 v90, -v15, s30, v6
    v_fma_f32 v91, v14, s30, v7
    v_mul_f32_e64 v4, v84, v61
    v_mul_f32_e64 v5, v84, -v62
    v_mfma_f32_32x32x16_bf16 v[240:255], v[148:151], v[132:135], v[240:255]
    v_fma_f32 v4, -v85, -v62, v4
    v_fma_f32 v5, v85, v61, v5
    v_mul_f32_e64 v6, v76, v63
    v_mul_f32_e64 v7, v76, -v64
    v_fma_f32 v6, -v77, -v64, v6
    v_fma_f32 v7, v77, v63, v7
    v_mfma_f32_32x32x16_bf16 v[192:207], v[152:155], v[136:139], v[192:207]
    v_mul_f32_e64 v8, v88, v65
    v_mul_f32_e64 v9, v88, -v66
    v_fma_f32 v8, -v89, -v66, v8
    v_fma_f32 v9, v89, v65, v9
    v_mul_f32_e64 v12, v18, v67
    v_mul_f32_e64 v13, v18, -v68
    v_mfma_f32_32x32x16_bf16 v[224:239], v[156:159], v[136:139], v[224:239]
    v_fma_f32 v12, -v19, -v68, v12
    v_fma_f32 v13, v19, v67, v13
    v_mul_f32_e64 v14, v86, v69
    v_mul_f32_e64 v15, v86, -v70
    v_fma_f32 v14, -v87, -v70, v14
    v_fma_f32 v15, v87, v69, v15
    v_mfma_f32_32x32x16_bf16 v[208:223], v[152:155], v[140:143], v[208:223]
    v_mul_f32_e64 v16, v78, v71
    v_mul_f32_e64 v17, v78, -v72
    v_fma_f32 v16, -v79, -v72, v16
    v_fma_f32 v17, v79, v71, v17
    v_mul_f32_e64 v18, v90, v73
    v_mul_f32_e64 v19, v90, -v74
    v_mfma_f32_32x32x16_bf16 v[240:255], v[156:159], v[140:143], v[240:255]
    v_fma_f32 v18, -v91, -v74, v18
    v_fma_f32 v19, v91, v73, v19
    ds_write_b64 v32, v[10:11] offset:16384
    ds_write_b64 v32, v[4:5] offset:16392
    ds_write_b64 v32, v[6:7] offset:16400
    ds_write_b64 v32, v[8:9] offset:16408
    s_add_u32 s96, s60, 49152
    buffer_load_dwordx4 v[128:131], v95, s[16:19], s96 offen offset:2048
    buffer_load_dwordx4 v[136:139], v95, s[16:19], s96 offen offset:3072
    s_add_u32 s96, s60, 137216
    buffer_load_dwordx4 v[132:135], v95, s[16:19], s96 offen offset:2048
    buffer_load_dwordx4 v[140:143], v95, s[16:19], s96 offen offset:3072
    s_add_u32 s96, s61, 49152
    buffer_load_dwordx4 v[144:147], v95, s[20:23], s96 offen offset:2048
    buffer_load_dwordx4 v[152:155], v95, s[20:23], s96 offen offset:3072
    s_add_u32 s96, s61, 147456
    buffer_load_dwordx4 v[148:151], v95, s[20:23], s96 offen offset:2048
    buffer_load_dwordx4 v[156:159], v95, s[20:23], s96 offen offset:3072
    s_waitcnt vmcnt(16)
    v_mfma_f32_32x32x16_bf16 v[192:207], v[176:179], v[160:163], v[192:207]
    ds_write_b64 v32, v[12:13] offset:16416
    ds_write_b64 v32, v[14:15] offset:16424
    ds_write_b64 v32, v[16:17] offset:16432
    ds_write_b64 v32, v[18:19] offset:16440
    s_waitcnt lgkmcnt(0)
    ds_read_b64 v[4:5], v31 offset:16384
    v_mfma_f32_32x32x16_bf16 v[224:239], v[180:183], v[160:163], v[224:239]
    ds_read_b64 v[6:7], v31 offset:16456
    ds_read_b64 v[8:9], v31 offset:16528
    ds_read_b64 v[10:11], v31 offset:16600
    ds_read_b64 v[12:13], v31 offset:16416
    ds_read_b64 v[14:15], v31 offset:16488
    ds_read_b64 v[16:17], v31 offset:16560
    v_mfma_f32_32x32x16_bf16 v[208:223], v[176:179], v[164:167], v[208:223]
    ds_read_b64 v[18:19], v31 offset:16632
    s_waitcnt lgkmcnt(0)
    v_add_f32 v76, v4, v8
    v_add_f32 v77, v5, v9
    v_sub_f32 v78, v4, v8
    v_sub_f32 v79, v5, v9
    v_mfma_f32_32x32x16_bf16 v[240:255], v[180:183], v[164:167], v[240:255]
    v_add_f32 v80, v6, v10
    v_add_f32 v81, v7, v11
    v_sub_f32 v82, v6, v10
    v_sub_f32 v83, v7, v11
    v_add_f32 v4, v76, v80
    v_add_f32 v5, v77, v81
    v_mfma_f32_32x32x16_bf16 v[192:207], v[184:187], v[168:171], v[192:207]
    v_sub_f32 v6, v76, v80
    v_sub_f32 v7, v77, v81
    v_add_f32 v8, v78, v83
    v_sub_f32 v9, v79, v82
    v_sub_f32 v10, v78, v83
    v_add_f32 v11, v79, v82
    v_mfma_f32_32x32x16_bf16 v[224:239], v[188:191], v[168:171], v[224:239]
    v_add_f32 v76, v12, v16
    v_add_f32 v77, v13, v17
    v_sub_f32 v78, v12, v16
    v_sub_f32 v79, v13, v17
    v_add_f32 v80, v14, v18
    v_add_f32 v81, v15, v19
    v_mfma_f32_32x32x16_bf16 v[208:223], v[184:187], v[172:175], v[208:223]
    v_sub_f32 v82, v14, v18
    v_sub_f32 v83, v15, v19
    v_add_f32 v12, v76, v80
    v_add_f32 v13, v77, v81
    v_sub_f32 v14, v76, v80
    v_sub_f32 v15, v77, v81
    v_mfma_f32_32x32x16_bf16 v[240:255], v[188:191], v[172:175], v[240:255]
    v_add_f32 v16, v78, v83
    v_sub_f32 v17, v79, v82
    v_sub_f32 v18, v78, v83
    v_add_f32 v19, v79, v82
    v_lshlrev_b32 v2, 16, v20
    v_and_b32 v33, 0xffff0000, v20
    s_add_u32 s96, s60, 65536
    buffer_load_dwordx4 v[160:163], v95, s[16:19], s96 offen offset:0
    buffer_load_dwordx4 v[168:171], v95, s[16:19], s96 offen offset:1024
    s_add_u32 s96, s60, 153600
    buffer_load_dwordx4 v[164:167], v95, s[16:19], s96 offen offset:0
    buffer_load_dwordx4 v[172:175], v95, s[16:19], s96 offen offset:1024
    s_add_u32 s96, s61, 65536
    buffer_load_dwordx4 v[176:179], v95, s[20:23], s96 offen offset:0
    buffer_load_dwordx4 v[184:187], v95, s[20:23], s96 offen offset:1024
    s_add_u32 s96, s61, 163840
    buffer_load_dwordx4 v[180:183], v95, s[20:23], s96 offen offset:0
    buffer_load_dwordx4 v[188:191], v95, s[20:23], s96 offen offset:1024
    s_waitcnt vmcnt(16)
    v_mfma_f32_32x32x16_bf16 v[192:207], v[112:115], v[96:99], v[192:207]
    v_mul_f32 v2, 0x35000000, v2
    v_mul_f32 v33, 0x35000000, v33
    v_mul_f32_e64 v76, v4, v2
    v_mul_f32_e64 v77, v4, v33
    v_fma_f32 v76, -v5, v33, v76
    v_fma_f32 v77, v5, v2, v77
    v_mfma_f32_32x32x16_bf16 v[224:239], v[116:119], v[96:99], v[224:239]
    v_lshlrev_b32 v2, 16, v21
    v_and_b32 v33, 0xffff0000, v21
    v_mul_f32 v2, 0x35000000, v2
    v_mul_f32 v33, 0x35000000, v33
    v_mul_f32_e64 v4, v8, v2
    v_mul_f32_e64 v5, v8, v33
    v_mfma_f32_32x32x16_bf16 v[208:223], v[112:115], v[100:103], v[208:223]
    v_fma_f32 v4, -v9, v33, v4
    v_fma_f32 v5, v9, v2, v5
    v_lshlrev_b32 v2, 16, v22
    v_and_b32 v33, 0xffff0000, v22
    v_mul_f32 v2, 0x35000000, v2
    v_mul_f32 v33, 0x35000000, v33
    v_mfma_f32_32x32x16_bf16 v[240:255], v[116:119], v[100:103], v[240:255]
    v_mul_f32_e64 v8, v6, v2
    v_mul_f32_e64 v9, v6, v33
    v_fma_f32 v8, -v7, v33, v8
    v_fma_f32 v9, v7, v2, v9
    v_lshlrev_b32 v2, 16, v23
    v_and_b32 v33, 0xffff0000, v23
    v_mfma_f32_32x32x16_bf16 v[192:207], v[120:123], v[104:107], v[192:207]
    v_mul_f32 v2, 0x35000000, v2
    v_mul_f32 v33, 0x35000000, v33
    v_mul_f32_e64 v6, v10, v2
    v_mul_f32_e64 v7, v10, v33
    v_fma_f32 v6, -v11, v33, v6
    v_fma_f32 v7, v11, v2, v7
    v_mfma_f32_32x32x16_bf16 v[224:239], v[124:127], v[104:107], v[224:239]
    v_lshlrev_b32 v2, 16, v24
    v_and_b32 v33, 0xffff0000, v24
    v_mul_f32 v2, 0x35000000, v2
    v_mul_f32 v33, 0x35000000, v33
    v_mul_f32_e64 v10, v12, v2
    v_mul_f32_e64 v11, v12, v33
    v_mfma_f32_32x32x16_bf16 v[208:223], v[120:123], v[108:111], v[208:223]
    v_fma_f32 v10, -v13, v33, v10
    v_fma_f32 v11, v13, v2, v11
    v_lshlrev_b32 v2, 16, v25
    v_and_b32 v33, 0xffff0000, v25
    v_mul_f32 v2, 0x35000000, v2
    v_mul_f32 v33, 0x35000000, v33
    v_mfma_f32_32x32x16_bf16 v[240:255], v[124:127], v[108:111], v[240:255]
    v_mul_f32_e64 v12, v16, v2
    v_mul_f32_e64 v13, v16, v33
    v_fma_f32 v12, -v17, v33, v12
    v_fma_f32 v13, v17, v2, v13
    v_lshlrev_b32 v2, 16, v26
    v_and_b32 v33, 0xffff0000, v26
    s_add_u32 s96, s60, 65536
    buffer_load_dwordx4 v[96:99], v95, s[16:19], s96 offen offset:2048
    buffer_load_dwordx4 v[104:107], v95, s[16:19], s96 offen offset:3072
    s_add_u32 s96, s60, 153600
    buffer_load_dwordx4 v[100:103], v95, s[16:19], s96 offen offset:2048
    buffer_load_dwordx4 v[108:111], v95, s[16:19], s96 offen offset:3072
    s_add_u32 s96, s61, 65536
    buffer_load_dwordx4 v[112:115], v95, s[20:23], s96 offen offset:2048
    buffer_load_dwordx4 v[120:123], v95, s[20:23], s96 offen offset:3072
    s_add_u32 s96, s61, 163840
    buffer_load_dwordx4 v[116:119], v95, s[20:23], s96 offen offset:2048
    buffer_load_dwordx4 v[124:127], v95, s[20:23], s96 offen offset:3072
    s_waitcnt vmcnt(16)
    v_mfma_f32_32x32x16_bf16 v[192:207], v[144:147], v[128:131], v[192:207]
    v_mul_f32 v2, 0x35000000, v2
    v_mul_f32 v33, 0x35000000, v33
    v_mul_f32_e64 v16, v14, v2
    v_mul_f32_e64 v17, v14, v33
    v_fma_f32 v16, -v15, v33, v16
    v_fma_f32 v17, v15, v2, v17
    v_mfma_f32_32x32x16_bf16 v[224:239], v[148:151], v[128:131], v[224:239]
    v_lshlrev_b32 v2, 16, v27
    v_and_b32 v33, 0xffff0000, v27
    v_mul_f32 v2, 0x35000000, v2
    v_mul_f32 v33, 0x35000000, v33
    v_mul_f32_e64 v14, v18, v2
    v_mul_f32_e64 v15, v18, v33
    v_mfma_f32_32x32x16_bf16 v[208:223], v[144:147], v[132:135], v[208:223]
    v_fma_f32 v14, -v19, v33, v14
    v_fma_f32 v15, v19, v2, v15
    v_add_f32 v18, v76, v8
    v_add_f32 v19, v77, v9
    v_sub_f32 v20, v76, v8
    v_sub_f32 v21, v77, v9
    v_mfma_f32_32x32x16_bf16 v[240:255], v[148:151], v[132:135], v[240:255]
    v_add_f32 v22, v4, v6
    v_add_f32 v23, v5, v7
    v_sub_f32 v24, v4, v6
    v_sub_f32 v25, v5, v7
    v_add_f32 v4, v18, v22
    v_add_f32 v5, v19, v23
    v_mfma_f32_32x32x16_bf16 v[192:207], v[152:155], v[136:139], v[192:207]
    v_sub_f32 v6, v18, v22
    v_sub_f32 v7, v19, v23
    v_sub_f32 v8, v20, v25
    v_add_f32 v9, v21, v24
    v_add_f32 v26, v20, v25
    v_sub_f32 v27, v21, v24
    v_mfma_f32_32x32x16_bf16 v[224:239], v[156:159], v[136:139], v[224:239]
    v_add_f32 v18, v10, v16
    v_add_f32 v19, v11, v17
    v_sub_f32 v20, v10, v16
    v_sub_f32 v21, v11, v17
    v_add_f32 v22, v12, v14
    v_add_f32 v23, v13, v15
    v_mfma_f32_32x32x16_bf16 v[208:223], v[152:155], v[140:143], v[208:223]
    v_sub_f32 v24, v12, v14
    v_sub_f32 v25, v13, v15
    v_add_f32 v10, v18, v22
    v_add_f32 v11, v19, v23
    v_sub_f32 v12, v18, v22
    v_sub_f32 v13, v19, v23
    v_mfma_f32_32x32x16_bf16 v[240:255], v[156:159], v[140:143], v[240:255]
    v_sub_f32 v14, v20, v25
    v_add_f32 v15, v21, v24
    v_add_f32 v16, v20, v25
    v_sub_f32 v17, v21, v24
    ds_write_b64 v31, v[4:5] offset:16384
    ds_write_b64 v31, v[8:9] offset:16456
    s_add_u32 s96, s60, 81920
    buffer_load_dwordx4 v[128:131], v95, s[16:19], s96 offen offset:0
    buffer_load_dwordx4 v[136:139], v95, s[16:19], s96 offen offset:1024
    s_add_u32 s96, s60, 169984
    buffer_load_dwordx4 v[132:135], v95, s[16:19], s96 offen offset:0
    buffer_load_dwordx4 v[140:143], v95, s[16:19], s96 offen offset:1024
    s_add_u32 s96, s61, 81920
    buffer_load_dwordx4 v[144:147], v95, s[20:23], s96 offen offset:0
    buffer_load_dwordx4 v[152:155], v95, s[20:23], s96 offen offset:1024
    s_add_u32 s96, s61, 180224
    buffer_load_dwordx4 v[148:151], v95, s[20:23], s96 offen offset:0
    buffer_load_dwordx4 v[156:159], v95, s[20:23], s96 offen offset:1024
    s_waitcnt vmcnt(16)
    v_mfma_f32_32x32x16_bf16 v[192:207], v[176:179], v[160:163], v[192:207]
    ds_write_b64 v31, v[6:7] offset:16528
    ds_write_b64 v31, v[26:27] offset:16600
    ds_write_b64 v31, v[10:11] offset:16416
    ds_write_b64 v31, v[14:15] offset:16488
    ds_write_b64 v31, v[12:13] offset:16560
    ds_write_b64 v31, v[16:17] offset:16632
    v_mfma_f32_32x32x16_bf16 v[224:239], v[180:183], v[160:163], v[224:239]
    s_waitcnt lgkmcnt(0)
    ds_read_b64 v[4:5], v32 offset:16384
    ds_read_b64 v[6:7], v32 offset:16392
    ds_read_b64 v[8:9], v32 offset:16400
    ds_read_b64 v[10:11], v32 offset:16408
    ds_read_b64 v[12:13], v32 offset:16416
    v_mfma_f32_32x32x16_bf16 v[208:223], v[176:179], v[164:167], v[208:223]
    ds_read_b64 v[14:15], v32 offset:16424
    ds_read_b64 v[16:17], v32 offset:16432
    ds_read_b64 v[18:19], v32 offset:16440
    s_waitcnt lgkmcnt(0)
    v_mul_f32_e64 v20, v6, v61
    v_mul_f32_e64 v21, v6, v62
    v_mfma_f32_32x32x16_bf16 v[240:255], v[180:183], v[164:167], v[240:255]
    v_fma_f32 v20, -v7, v62, v20
    v_fma_f32 v21, v7, v61, v21
    v_mul_f32_e64 v6, v8, v63
    v_mul_f32_e64 v7, v8, v64
    v_fma_f32 v6, -v9, v64, v6
    v_fma_f32 v7, v9, v63, v7
    v_mfma_f32_32x32x16_bf16 v[192:207], v[184:187], v[168:171], v[192:207]
    v_mul_f32_e64 v8, v10, v65
    v_mul_f32_e64 v9, v10, v66
    v_fma_f32 v8, -v11, v66, v8
    v_fma_f32 v9, v11, v65, v9
    v_mul_f32_e64 v10, v12, v67
    v_mul_f32_e64 v11, v12, v68
    v_mfma_f32_32x32x16_bf16 v[224:239], v[188:191], v[168:171], v[224:239]
    v_fma_f32 v10, -v13, v68, v10
    v_fma_f32 v11, v13, v67, v11
    v_mul_f32_e64 v12, v14, v69
    v_mul_f32_e64 v13, v14, v70
    v_fma_f32 v12, -v15, v70, v12
    v_fma_f32 v13, v15, v69, v13
    v_mfma_f32_32x32x16_bf16 v[208:223], v[184:187], v[172:175], v[208:223]
    v_mul_f32_e64 v14, v16, v71
    v_mul_f32_e64 v15, v16, v72
    v_fma_f32 v14, -v17, v72, v14
    v_fma_f32 v15, v17, v71, v15
    v_mul_f32_e64 v16, v18, v73
    v_mul_f32_e64 v17, v18, v74
    v_mfma_f32_32x32x16_bf16 v[240:255], v[188:191], v[172:175], v[240:255]
    v_fma_f32 v16, -v19, v74, v16
    v_fma_f32 v17, v19, v73, v17
    v_add_f32 v18, v4, v10
    v_add_f32 v19, v5, v11
    v_sub_f32 v22, v4, v10
    v_sub_f32 v23, v5, v11
    s_add_u32 s96, s60, 81920
    buffer_load_dwordx4 v[160:163], v95, s[16:19], s96 offen offset:2048
    buffer_load_dwordx4 v[168:171], v95, s[16:19], s96 offen offset:3072
    s_add_u32 s96, s60, 169984
    buffer_load_dwordx4 v[164:167], v95, s[16:19], s96 offen offset:2048
    buffer_load_dwordx4 v[172:175], v95, s[16:19], s96 offen offset:3072
    s_add_u32 s96, s61, 81920
    buffer_load_dwordx4 v[176:179], v95, s[20:23], s96 offen offset:2048
    buffer_load_dwordx4 v[184:187], v95, s[20:23], s96 offen offset:3072
    s_add_u32 s96, s61, 180224
    buffer_load_dwordx4 v[180:183], v95, s[20:23], s96 offen offset:2048
    buffer_load_dwordx4 v[188:191], v95, s[20:23], s96 offen offset:3072
    s_waitcnt vmcnt(16)
    v_mfma_f32_32x32x16_bf16 v[192:207], v[112:115], v[96:99], v[192:207]
    v_add_f32 v4, v20, v12
    v_add_f32 v5, v21, v13
    v_sub_f32 v10, v20, v12
    v_sub_f32 v11, v21, v13
    v_add_f32 v12, v6, v14
    v_add_f32 v13, v7, v15
    v_mfma_f32_32x32x16_bf16 v[224:239], v[116:119], v[96:99], v[224:239]
    v_sub_f32 v20, v6, v14
    v_sub_f32 v21, v7, v15
    v_add_f32 v6, v8, v16
    v_add_f32 v7, v9, v17
    v_sub_f32 v14, v8, v16
    v_sub_f32 v15, v9, v17
    v_mfma_f32_32x32x16_bf16 v[208:223], v[112:115], v[100:103], v[208:223]
    v_sub_f32 v8, v10, v11
    v_add_f32 v9, v11, v10
    v_add_f32 v16, v14, v15
    v_sub_f32 v17, v14, v15
    v_add_f32 v10, v18, v12
    v_add_f32 v11, v19, v13
    v_mfma_f32_32x32x16_bf16 v[240:255], v[116:119], v[100:103], v[240:255]
    v_sub_f32 v14, v18, v12
    v_sub_f32 v15, v19, v13
    v_add_f32 v24, v4, v6
    v_add_f32 v25, v5, v7
    v_sub_f32 v26, v4, v6
    v_sub_f32 v27, v5, v7
    v_mfma_f32_32x32x16_bf16 v[192:207], v[120:123], v[104:107], v[192:207]
    v_sub_f32 v4, v22, v21
    v_add_f32 v5, v23, v20
    v_add_f32 v6, v22, v21
    v_sub_f32 v7, v23, v20
    v_sub_f32 v12, v8, v16
    v_add_f32 v13, v9, v17
    v_mfma_f32_32x32x16_bf16 v[224:239], v[124:127], v[104:107], v[224:239]
    v_add_f32 v18, v8, v16
    v_sub_f32 v19, v9, v17
    v_add_f32 v8, v10, v24
    v_add_f32 v9, v11, v25
    v_sub_f32 v16, v10, v24
    v_sub_f32 v17, v11, v25
    v_mfma_f32_32x32x16_bf16 v[208:223], v[120:123], v[108:111], v[208:223]
    v_sub_f32 v20, v14, v27
    v_add_f32 v21, v15, v26
    v_add_f32 v22, v14, v27
    v_sub_f32 v23, v15, v26
    v_fma_f32 v76, v12, s30, v4
    v_fma_f32 v77, v13, s30, v5
    v_mfma_f32_32x32x16_bf16 v[240:255], v[124:127], v[108:111], v[240:255]
    v_fma_f32 v78, -v12, s30, v4
    v_fma_f32 v79, -v13, s30, v5
    v_fma_f32 v80, -v19, s30, v6
    v_fma_f32 v81, v18, s30, v7
    v_fma_f32 v82, v19, s30, v6
    v_fma_f32 v83, -v18, s30, v7
    s_waitcnt vmcnt(8)
    v_mfma_f32_32x32x16_bf16 v[192:207], v[144:147], v[128:131], v[192:207]
    ds_write_b64 v31, v[8:9] offset:16384
    ds_write_b64 v31, v[76:77] offset:16416
    ds_write_b64 v31, v[20:21] offset:16448
    ds_write_b64 v31, v[80:81] offset:16480
    ds_write_b64 v31, v[16:17] offset:16512
    ds_write_b64 v31, v[78:79] offset:16544
    v_mfma_f32_32x32x16_bf16 v[224:239], v[148:151], v[128:131], v[224:239]
    ds_write_b64 v31, v[22:23] offset:16576
    ds_write_b64 v31, v[82:83] offset:16608
    s_waitcnt lgkmcnt(0)
    ds_read_b64 v[4:5], v30 offset:16384
    ds_read_b64 v[6:7], v30 offset:16672
    ds_read_b64 v[8:9], v30 offset:16960
    v_mfma_f32_32x32x16_bf16 v[208:223], v[144:147], v[132:135], v[208:223]
    ds_read_b64 v[10:11], v30 offset:17248
    ds_read_b64 v[12:13], v30 offset:17536
    ds_read_b64 v[14:15], v30 offset:17824
    ds_read_b64 v[16:17], v30 offset:18112
    ds_read_b64 v[18:19], v30 offset:18400
    s_waitcnt lgkmcnt(0)
    v_mfma_f32_32x32x16_bf16 v[240:255], v[148:151], v[132:135], v[240:255]
    v_mul_f32_e64 v20, v6, v47
    v_mul_f32_e64 v21, v6, v48
    v_fma_f32 v20, -v7, v48, v20
    v_fma_f32 v21, v7, v47, v21
    v_mul_f32_e64 v6, v8, v49
    v_mul_f32_e64 v7, v8, v50
    v_mfma_f32_32x32x16_bf16 v[192:207], v[152:155], v[136:139], v[192:207]
    v_fma_f32 v6, -v9, v50, v6
    v_fma_f32 v7, v9, v49, v7
    v_mul_f32_e64 v8, v10, v51
    v_mul_f32_e64 v9, v10, v52
    v_fma_f32 v8, -v11, v52, v8
    v_fma_f32 v9, v11, v51, v9
    v_mfma_f32_32x32x16_bf16 v[224:239], v[156:159], v[136:139], v[224:239]
    v_mul_f32_e64 v10, v12, v53
    v_mul_f32_e64 v11, v12, v54
    v_fma_f32 v10, -v13, v54, v10
    v_fma_f32 v11, v13, v53, v11
    v_mul_f32_e64 v12, v14, v55
    v_mul_f32_e64 v13, v14, v56
    v_mfma_f32_32x32x16_bf16 v[208:223], v[152:155], v[140:143], v[208:223]
    v_fma_f32 v12, -v15, v56, v12
    v_fma_f32 v13, v15, v55, v13
    v_mul_f32_e64 v14, v16, v57
    v_mul_f32_e64 v15, v16, v58
    v_fma_f32 v14, -v17, v58, v14
    v_fma_f32 v15, v17, v57, v15
    v_mfma_f32_32x32x16_bf16 v[240:255], v[156:159], v[140:143], v[240:255]
    v_mul_f32_e64 v16, v18, v59
    v_mul_f32_e64 v17, v18, v60
    v_fma_f32 v16, -v19, v60, v16
    v_fma_f32 v17, v19, v59, v17
    v_add_f32 v18, v4, v10
    v_add_f32 v19, v5, v11
    s_waitcnt vmcnt(0)
    v_mfma_f32_32x32x16_bf16 v[192:207], v[176:179], v[160:163], v[192:207]
    v_sub_f32 v22, v4, v10
    v_sub_f32 v23, v5, v11
    v_add_f32 v4, v20, v12
    v_add_f32 v5, v21, v13
    v_sub_f32 v10, v20, v12
    v_sub_f32 v11, v21, v13
    v_mfma_f32_32x32x16_bf16 v[224:239], v[180:183], v[160:163], v[224:239]
    v_add_f32 v12, v6, v14
    v_add_f32 v13, v7, v15
    v_sub_f32 v20, v6, v14
    v_sub_f32 v21, v7, v15
    v_add_f32 v6, v8, v16
    v_add_f32 v7, v9, v17
    v_mfma_f32_32x32x16_bf16 v[208:223], v[176:179], v[164:167], v[208:223]
    v_sub_f32 v14, v8, v16
    v_sub_f32 v15, v9, v17
    v_sub_f32 v8, v10, v11
    v_add_f32 v9, v11, v10
    v_add_f32 v16, v14, v15
    v_sub_f32 v17, v14, v15
    v_mfma_f32_32x32x16_bf16 v[240:255], v[180:183], v[164:167], v[240:255]
    v_add_f32 v10, v18, v12
    v_add_f32 v11, v19, v13
    v_sub_f32 v14, v18, v12
    v_sub_f32 v15, v19, v13
    v_add_f32 v24, v4, v6
    v_add_f32 v25, v5, v7
    v_mfma_f32_32x32x16_bf16 v[192:207], v[184:187], v[168:171], v[192:207]
    v_sub_f32 v26, v4, v6
    v_sub_f32 v27, v5, v7
    v_sub_f32 v4, v22, v21
    v_add_f32 v5, v23, v20
    v_add_f32 v6, v22, v21
    v_sub_f32 v7, v23, v20
    v_mfma_f32_32x32x16_bf16 v[224:239], v[188:191], v[168:171], v[224:239]
    v_sub_f32 v12, v8, v16
    v_add_f32 v13, v9, v17
    v_add_f32 v18, v8, v16
    v_sub_f32 v19, v9, v17
    v_add_f32 v8, v10, v24
    v_add_f32 v9, v11, v25
    v_mfma_f32_32x32x16_bf16 v[208:223], v[184:187], v[172:175], v[208:223]
    v_sub_f32 v16, v10, v24
    v_sub_f32 v17, v11, v25
    v_sub_f32 v20, v14, v27
    v_add_f32 v21, v15, v26
    v_add_f32 v22, v14, v27
    v_sub_f32 v23, v15, v26
    v_mfma_f32_32x32x16_bf16 v[240:255], v[188:191], v[172:175], v[240:255]
    v_fma_f32 v76, v12, s30, v4
    v_fma_f32 v77, v13, s30, v5
    v_fma_f32 v78, -v12, s30, v4
    v_fma_f32 v79, -v13, s30, v5
    v_fma_f32 v80, -v19, s30, v6
    v_fma_f32 v81, v18, s30, v7
    v_fma_f32 v82, v19, s30, v6
    v_fma_f32 v83, -v18, s30, v7
    ds_write_b64 v29, v[8:9] offset:34816
    ds_write_b64 v29, v[76:77] offset:35072
    ds_write_b64 v29, v[20:21] offset:35328
    ds_write_b64 v29, v[80:81] offset:35584
    ds_write_b64 v29, v[16:17] offset:35840
    ds_write_b64 v29, v[78:79] offset:36096
    ds_write_b64 v29, v[22:23] offset:36352
    ds_write_b64 v29, v[82:83] offset:36608
    s_waitcnt lgkmcnt(0)
    s_barrier
    ds_read_b64 v[4:5], v1 offset:34816
    ds_read_b64 v[6:7], v1 offset:36864
    ds_read_b64 v[8:9], v1 offset:38912
    ds_read_b64 v[10:11], v1 offset:40960
    ds_read_b64 v[12:13], v1 offset:43008
    ds_read_b64 v[14:15], v1 offset:45056
    ds_read_b64 v[16:17], v1 offset:47104
    ds_read_b64 v[18:19], v1 offset:49152
    s_waitcnt lgkmcnt(0)
    v_mul_f32_e64 v20, v6, v3
    v_mul_f32_e64 v21, v6, v28
    v_fma_f32 v20, -v7, v28, v20
    v_fma_f32 v21, v7, v3, v21
    v_mul_f32_e64 v6, v8, v35
    v_mul_f32_e64 v7, v8, v36
    v_fma_f32 v6, -v9, v36, v6
    v_fma_f32 v7, v9, v35, v7
    v_mul_f32_e64 v8, v10, v37
    v_mul_f32_e64 v9, v10, v38
    v_fma_f32 v8, -v11, v38, v8
    v_fma_f32 v9, v11, v37, v9
    v_mul_f32_e64 v10, v12, v39
    v_mul_f32_e64 v11, v12, v40
    v_fma_f32 v10, -v13, v40, v10
    v_fma_f32 v11, v13, v39, v11
    v_mul_f32_e64 v12, v14, v41
    v_mul_f32_e64 v13, v14, v42
    v_fma_f32 v12, -v15, v42, v12
    v_fma_f32 v13, v15, v41, v13
    v_mul_f32_e64 v14, v16, v43
    v_mul_f32_e64 v15, v16, v44
    v_fma_f32 v14, -v17, v44, v14
    v_fma_f32 v15, v17, v43, v15
    v_mul_f32_e64 v16, v18, v45
    v_mul_f32_e64 v17, v18, v46
    v_fma_f32 v16, -v19, v46, v16
    v_fma_f32 v17, v19, v45, v17
    v_add_f32 v18, v4, v10
    v_add_f32 v19, v5, v11
    v_sub_f32 v22, v4, v10
    v_sub_f32 v23, v5, v11
    v_add_f32 v4, v20, v12
    v_add_f32 v5, v21, v13
    v_sub_f32 v10, v20, v12
    v_sub_f32 v11, v21, v13
    v_add_f32 v12, v6, v14
    v_add_f32 v13, v7, v15
    v_sub_f32 v20, v6, v14
    v_sub_f32 v21, v7, v15
    v_add_f32 v6, v8, v16
    v_add_f32 v7, v9, v17
    v_sub_f32 v14, v8, v16
    v_sub_f32 v15, v9, v17
    v_sub_f32 v8, v10, v11
    v_add_f32 v9, v11, v10
    v_add_f32 v16, v14, v15
    v_sub_f32 v17, v14, v15
    v_add_f32 v10, v18, v12
    v_add_f32 v11, v19, v13
    v_sub_f32 v14, v18, v12
    v_sub_f32 v15, v19, v13
    v_add_f32 v24, v4, v6
    v_add_f32 v25, v5, v7
    v_sub_f32 v26, v4, v6
    v_sub_f32 v27, v5, v7
    v_sub_f32 v4, v22, v21
    v_add_f32 v5, v23, v20
    v_add_f32 v6, v22, v21
    v_sub_f32 v7, v23, v20
    v_sub_f32 v12, v8, v16
    v_add_f32 v13, v9, v17
    v_add_f32 v18, v8, v16
    v_sub_f32 v19, v9, v17
    v_add_f32 v8, v10, v24
    v_add_f32 v9, v11, v25
    v_sub_f32 v16, v10, v24
    v_sub_f32 v17, v11, v25
    v_sub_f32 v20, v14, v27
    v_add_f32 v21, v15, v26
    v_add_f32 v22, v14, v27
    v_sub_f32 v23, v15, v26
    v_fma_f32 v76, v12, s30, v4
    v_fma_f32 v77, v13, s30, v5
    v_fma_f32 v78, -v12, s30, v4
    v_fma_f32 v79, -v13, s30, v5
    v_fma_f32 v80, -v19, s30, v6
    v_fma_f32 v81, v18, s30, v7
    v_fma_f32 v82, v19, s30, v6
    v_fma_f32 v83, -v18, s30, v7
    s_add_u32 s31, s14, 0
    buffer_store_dwordx2 v[8:9], v1, s[24:27], s31 offen
    s_add_u32 s31, s14, 2048
    buffer_store_dwordx2 v[76:77], v1, s[24:27], s31 offen
    s_add_u32 s31, s14, 4096
    buffer_store_dwordx2 v[20:21], v1, s[24:27], s31 offen
    s_add_u32 s31, s14, 6144
    buffer_store_dwordx2 v[80:81], v1, s[24:27], s31 offen
    s_add_u32 s31, s14, 8192
    buffer_store_dwordx2 v[16:17], v1, s[24:27], s31 offen
    s_add_u32 s31, s14, 10240
    buffer_store_dwordx2 v[78:79], v1, s[24:27], s31 offen
    s_add_u32 s31, s14, 12288
    buffer_store_dwordx2 v[22:23], v1, s[24:27], s31 offen
    s_add_u32 s31, s14, 14336
    buffer_store_dwordx2 v[82:83], v1, s[24:27], s31 offen
    s_nop 15
    s_waitcnt lgkmcnt(0)
    s_barrier
    v_and_b32 v2, 63, v0
    v_lshlrev_b32 v1, 4, v2
    s_cmp_eq_u32 s3, 1
    s_cbranch_scc1 G2R_8
    s_cmp_eq_u32 s3, 2
    s_cbranch_scc1 G2R_9
    s_cmp_eq_u32 s3, 3
    s_cbranch_scc1 G2R_10
G2R_7:
    ds_write_b128 v1, v[208:211] offset:20480
    ds_write_b128 v1, v[212:215] offset:21504
    ds_write_b128 v1, v[216:219] offset:22528
    ds_write_b128 v1, v[220:223] offset:23552
    ds_write_b128 v1, v[224:227] offset:28672
    ds_write_b128 v1, v[228:231] offset:29696
    ds_write_b128 v1, v[232:235] offset:30720
    ds_write_b128 v1, v[236:239] offset:31744
    ds_write_b128 v1, v[240:243] offset:36864
    ds_write_b128 v1, v[244:247] offset:37888
    ds_write_b128 v1, v[248:251] offset:38912
    ds_write_b128 v1, v[252:255] offset:39936
    s_waitcnt lgkmcnt(0)
    s_barrier
    ds_read_b128 v[16:19], v1 offset:0
    ds_read_b128 v[20:23], v1 offset:1024
    ds_read_b128 v[24:27], v1 offset:2048
    ds_read_b128 v[28:31], v1 offset:3072
    ds_read_b128 v[32:35], v1 offset:4096
    ds_read_b128 v[36:39], v1 offset:5120
    ds_read_b128 v[40:43], v1 offset:6144
    ds_read_b128 v[44:47], v1 offset:7168
    ds_read_b128 v[48:51], v1 offset:8192
    ds_read_b128 v[52:55], v1 offset:9216
    ds_read_b128 v[56:59], v1 offset:10240
    ds_read_b128 v[60:63], v1 offset:11264
    s_waitcnt lgkmcnt(0)
    v_add_f32 v16, v16, v32
    v_add_f32 v48, v48, v192
    v_add_f32 v17, v17, v33
    v_add_f32 v49, v49, v193
    v_add_f32 v18, v18, v34
    v_add_f32 v50, v50, v194
    v_add_f32 v19, v19, v35
    v_add_f32 v51, v51, v195
    v_add_f32 v20, v20, v36
    v_add_f32 v52, v52, v196
    v_add_f32 v21, v21, v37
    v_add_f32 v53, v53, v197
    v_add_f32 v22, v22, v38
    v_add_f32 v54, v54, v198
    v_add_f32 v23, v23, v39
    v_add_f32 v55, v55, v199
    v_add_f32 v24, v24, v40
    v_add_f32 v56, v56, v200
    v_add_f32 v25, v25, v41
    v_add_f32 v57, v57, v201
    v_add_f32 v26, v26, v42
    v_add_f32 v58, v58, v202
    v_add_f32 v27, v27, v43
    v_add_f32 v59, v59, v203
    v_add_f32 v28, v28, v44
    v_add_f32 v60, v60, v204
    v_add_f32 v29, v29, v45
    v_add_f32 v61, v61, v205
    v_add_f32 v30, v30, v46
    v_add_f32 v62, v62, v206
    v_add_f32 v31, v31, v47
    v_add_f32 v63, v63, v207
    v_add_f32 v16, v16, v48
    v_add_f32 v17, v17, v49
    v_add_f32 v18, v18, v50
    v_add_f32 v19, v19, v51
    v_add_f32 v20, v20, v52
    v_add_f32 v21, v21, v53
    v_add_f32 v22, v22, v54
    v_add_f32 v23, v23, v55
    v_add_f32 v24, v24, v56
    v_add_f32 v25, v25, v57
    v_add_f32 v26, v26, v58
    v_add_f32 v27, v27, v59
    v_add_f32 v28, v28, v60
    v_add_f32 v29, v29, v61
    v_add_f32 v30, v30, v62
    v_add_f32 v31, v31, v63
    s_branch G2RJ_11
G2R_8:
    ds_write_b128 v1, v[192:195] offset:0
    ds_write_b128 v1, v[196:199] offset:1024
    ds_write_b128 v1, v[200:203] offset:2048
    ds_write_b128 v1, v[204:207] offset:3072
    ds_write_b128 v1, v[224:227] offset:32768
    ds_write_b128 v1, v[228:231] offset:33792
    ds_write_b128 v1, v[232:235] offset:34816
    ds_write_b128 v1, v[236:239] offset:35840
    ds_write_b128 v1, v[240:243] offset:40960
    ds_write_b128 v1, v[244:247] offset:41984
    ds_write_b128 v1, v[248:251] offset:43008
    ds_write_b128 v1, v[252:255] offset:44032
    s_waitcnt lgkmcnt(0)
    s_barrier
    ds_read_b128 v[16:19], v1 offset:12288
    ds_read_b128 v[20:23], v1 offset:13312
    ds_read_b128 v[24:27], v1 offset:14336
    ds_read_b128 v[28:31], v1 offset:15360
    ds_read_b128 v[32:35], v1 offset:16384
    ds_read_b128 v[36:39], v1 offset:17408
    ds_read_b128 v[40:43], v1 offset:18432
    ds_read_b128 v[44:47], v1 offset:19456
    ds_read_b128 v[48:51], v1 offset:20480
    ds_read_b128 v[52:55], v1 offset:21504
    ds_read_b128 v[56:59], v1 offset:22528
    ds_read_b128 v[60:63], v1 offset:23552
    s_waitcnt lgkmcnt(0)
    v_add_f32 v16, v16, v32
    v_add_f32 v48, v48, v208
    v_add_f32 v17, v17, v33
    v_add_f32 v49, v49, v209
    v_add_f32 v18, v18, v34
    v_add_f32 v50, v50, v210
    v_add_f32 v19, v19, v35
    v_add_f32 v51, v51, v211
    v_add_f32 v20, v20, v36
    v_add_f32 v52, v52, v212
    v_add_f32 v21, v21, v37
    v_add_f32 v53, v53, v213
    v_add_f32 v22, v22, v38
    v_add_f32 v54, v54, v214
    v_add_f32 v23, v23, v39
    v_add_f32 v55, v55, v215
    v_add_f32 v24, v24, v40
    v_add_f32 v56, v56, v216
    v_add_f32 v25, v25, v41
    v_add_f32 v57, v57, v217
    v_add_f32 v26, v26, v42
    v_add_f32 v58, v58, v218
    v_add_f32 v27, v27, v43
    v_add_f32 v59, v59, v219
    v_add_f32 v28, v28, v44
    v_add_f32 v60, v60, v220
    v_add_f32 v29, v29, v45
    v_add_f32 v61, v61, v221
    v_add_f32 v30, v30, v46
    v_add_f32 v62, v62, v222
    v_add_f32 v31, v31, v47
    v_add_f32 v63, v63, v223
    v_add_f32 v16, v16, v48
    v_add_f32 v17, v17, v49
    v_add_f32 v18, v18, v50
    v_add_f32 v19, v19, v51
    v_add_f32 v20, v20, v52
    v_add_f32 v21, v21, v53
    v_add_f32 v22, v22, v54
    v_add_f32 v23, v23, v55
    v_add_f32 v24, v24, v56
    v_add_f32 v25, v25, v57
    v_add_f32 v26, v26, v58
    v_add_f32 v27, v27, v59
    v_add_f32 v28, v28, v60
    v_add_f32 v29, v29, v61
    v_add_f32 v30, v30, v62
    v_add_f32 v31, v31, v63
    s_branch G2RJ_11
G2R_9:
    ds_write_b128 v1, v[192:195] offset:4096
    ds_write_b128 v1, v[196:199] offset:5120
    ds_write_b128 v1, v[200:203] offset:6144
    ds_write_b128 v1, v[204:207] offset:7168
    ds_write_b128 v1, v[208:211] offset:12288
    ds_write_b128 v1, v[212:215] offset:13312
    ds_write_b128 v1, v[216:219] offset:14336
    ds_write_b128 v1, v[220:223] offset:15360
    ds_write_b128 v1, v[240:243] offset:45056
    ds_write_b128 v1, v[244:247] offset:46080
    ds_write_b128 v1, v[248:251] offset:47104
    ds_write_b128 v1, v[252:255] offset:48128
    s_waitcnt lgkmcnt(0)
    s_barrier
    ds_read_b128 v[16:19], v1 offset:24576
    ds_read_b128 v[20:23], v1 offset:25600
    ds_read_b128 v[24:27], v1 offset:26624
    ds_read_b128 v[28:31], v1 offset:27648
    ds_read_b128 v[32:35], v1 offset:28672
    ds_read_b128 v[36:39], v1 offset:29696
    ds_read_b128 v[40:43], v1 offset:30720
    ds_read_b128 v[44:47], v1 offset:31744
    ds_read_b128 v[48:51], v1 offset:32768
    ds_read_b128 v[52:55], v1 offset:33792
    ds_read_b128 v[56:59], v1 offset:34816
    ds_read_b128 v[60:63], v1 offset:35840
    s_waitcnt lgkmcnt(0)
    v_add_f32 v16, v16, v32
    v_add_f32 v48, v48, v224
    v_add_f32 v17, v17, v33
    v_add_f32 v49, v49, v225
    v_add_f32 v18, v18, v34
    v_add_f32 v50, v50, v226
    v_add_f32 v19, v19, v35
    v_add_f32 v51, v51, v227
    v_add_f32 v20, v20, v36
    v_add_f32 v52, v52, v228
    v_add_f32 v21, v21, v37
    v_add_f32 v53, v53, v229
    v_add_f32 v22, v22, v38
    v_add_f32 v54, v54, v230
    v_add_f32 v23, v23, v39
    v_add_f32 v55, v55, v231
    v_add_f32 v24, v24, v40
    v_add_f32 v56, v56, v232
    v_add_f32 v25, v25, v41
    v_add_f32 v57, v57, v233
    v_add_f32 v26, v26, v42
    v_add_f32 v58, v58, v234
    v_add_f32 v27, v27, v43
    v_add_f32 v59, v59, v235
    v_add_f32 v28, v28, v44
    v_add_f32 v60, v60, v236
    v_add_f32 v29, v29, v45
    v_add_f32 v61, v61, v237
    v_add_f32 v30, v30, v46
    v_add_f32 v62, v62, v238
    v_add_f32 v31, v31, v47
    v_add_f32 v63, v63, v239
    v_add_f32 v16, v16, v48
    v_add_f32 v17, v17, v49
    v_add_f32 v18, v18, v50
    v_add_f32 v19, v19, v51
    v_add_f32 v20, v20, v52
    v_add_f32 v21, v21, v53
    v_add_f32 v22, v22, v54
    v_add_f32 v23, v23, v55
    v_add_f32 v24, v24, v56
    v_add_f32 v25, v25, v57
    v_add_f32 v26, v26, v58
    v_add_f32 v27, v27, v59
    v_add_f32 v28, v28, v60
    v_add_f32 v29, v29, v61
    v_add_f32 v30, v30, v62
    v_add_f32 v31, v31, v63
    s_branch G2RJ_11
G2R_10:
    ds_write_b128 v1, v[192:195] offset:8192
    ds_write_b128 v1, v[196:199] offset:9216
    ds_write_b128 v1, v[200:203] offset:10240
    ds_write_b128 v1, v[204:207] offset:11264
    ds_write_b128 v1, v[208:211] offset:16384
    ds_write_b128 v1, v[212:215] offset:17408
    ds_write_b128 v1, v[216:219] offset:18432
    ds_write_b128 v1, v[220:223] offset:19456
    ds_write_b128 v1, v[224:227] offset:24576
    ds_write_b128 v1, v[228:231] offset:25600
    ds_write_b128 v1, v[232:235] offset:26624
    ds_write_b128 v1, v[236:239] offset:27648
    s_waitcnt lgkmcnt(0)
    s_barrier
    ds_read_b128 v[16:19], v1 offset:36864
    ds_read_b128 v[20:23], v1 offset:37888
    ds_read_b128 v[24:27], v1 offset:38912
    ds_read_b128 v[28:31], v1 offset:39936
    ds_read_b128 v[32:35], v1 offset:40960
    ds_read_b128 v[36:39], v1 offset:41984
    ds_read_b128 v[40:43], v1 offset:43008
    ds_read_b128 v[44:47], v1 offset:44032
    ds_read_b128 v[48:51], v1 offset:45056
    ds_read_b128 v[52:55], v1 offset:46080
    ds_read_b128 v[56:59], v1 offset:47104
    ds_read_b128 v[60:63], v1 offset:48128
    s_waitcnt lgkmcnt(0)
    v_add_f32 v16, v16, v32
    v_add_f32 v48, v48, v240
    v_add_f32 v17, v17, v33
    v_add_f32 v49, v49, v241
    v_add_f32 v18, v18, v34
    v_add_f32 v50, v50, v242
    v_add_f32 v19, v19, v35
    v_add_f32 v51, v51, v243
    v_add_f32 v20, v20, v36
    v_add_f32 v52, v52, v244
    v_add_f32 v21, v21, v37
    v_add_f32 v53, v53, v245
    v_add_f32 v22, v22, v38
    v_add_f32 v54, v54, v246
    v_add_f32 v23, v23, v39
    v_add_f32 v55, v55, v247
    v_add_f32 v24, v24, v40
    v_add_f32 v56, v56, v248
    v_add_f32 v25, v25, v41
    v_add_f32 v57, v57, v249
    v_add_f32 v26, v26, v42
    v_add_f32 v58, v58, v250
    v_add_f32 v27, v27, v43
    v_add_f32 v59, v59, v251
    v_add_f32 v28, v28, v44
    v_add_f32 v60, v60, v252
    v_add_f32 v29, v29, v45
    v_add_f32 v61, v61, v253
    v_add_f32 v30, v30, v46
    v_add_f32 v62, v62, v254
    v_add_f32 v31, v31, v47
    v_add_f32 v63, v63, v255
    v_add_f32 v16, v16, v48
    v_add_f32 v17, v17, v49
    v_add_f32 v18, v18, v50
    v_add_f32 v19, v19, v51
    v_add_f32 v20, v20, v52
    v_add_f32 v21, v21, v53
    v_add_f32 v22, v22, v54
    v_add_f32 v23, v23, v55
    v_add_f32 v24, v24, v56
    v_add_f32 v25, v25, v57
    v_add_f32 v26, v26, v58
    v_add_f32 v27, v27, v59
    v_add_f32 v28, v28, v60
    v_add_f32 v29, v29, v61
    v_add_f32 v30, v30, v62
    v_add_f32 v31, v31, v63
G2RJ_11:
    v_cvt_pk_bf16_f32 v64, v16, v17
    v_cvt_pk_bf16_f32 v65, v18, v19
    v_cvt_pk_bf16_f32 v66, v20, v21
    v_cvt_pk_bf16_f32 v67, v22, v23
    v_cvt_pk_bf16_f32 v68, v24, v25
    v_cvt_pk_bf16_f32 v69, v26, v27
    v_cvt_pk_bf16_f32 v70, v28, v29
    v_cvt_pk_bf16_f32 v71, v30, v31
    v_permlane32_swap_b32 v64, v66
    v_permlane32_swap_b32 v65, v67
    v_permlane32_swap_b32 v68, v70
    v_permlane32_swap_b32 v69, v71
    v_and_b32 v3, 31, v2
    v_lshlrev_b32 v3, 10, v3
    v_lshrrev_b32 v4, 5, v2
    v_lshl_add_u32 v3, v4, 4, v3
    s_and_b32 s38, s3, 1
    s_lshl_b32 s39, s56, 1
    s_add_u32 s38, s38, s39
    s_lshl_b32 s38, s38, 15
    s_lshr_b32 s39, s3, 1
    s_lshl_b32 s40, s57, 1
    s_add_u32 s39, s39, s40
    s_lshl_b32 s39, s39, 6
    s_add_u32 s38, s38, s39
    buffer_store_dwordx4 v[64:67], v3, s[32:35], s38 offen offset:0
    buffer_store_dwordx4 v[68:71], v3, s[32:35], s38 offen offset:32
    s_endpgm
K2_FFTONLY:
    s_mul_i32 s14, s2, 16640
    s_mul_i32 s15, s2, 8448
    v_lshlrev_b32 v1, 3, v0
    v_lshlrev_b32 v2, 5, v0
    s_add_u32 s31, s14, 0
    buffer_load_dwordx2 v[4:5], v1, s[24:27], s31 offen
    s_add_u32 s31, s14, 2048
    buffer_load_dwordx2 v[6:7], v1, s[24:27], s31 offen
    s_add_u32 s31, s14, 4096
    buffer_load_dwordx2 v[8:9], v1, s[24:27], s31 offen
    s_add_u32 s31, s14, 6144
    buffer_load_dwordx2 v[10:11], v1, s[24:27], s31 offen
    s_add_u32 s31, s14, 8192
    buffer_load_dwordx2 v[12:13], v1, s[24:27], s31 offen
    s_add_u32 s31, s14, 10240
    buffer_load_dwordx2 v[14:15], v1, s[24:27], s31 offen
    s_add_u32 s31, s14, 12288
    buffer_load_dwordx2 v[16:17], v1, s[24:27], s31 offen
    s_add_u32 s31, s14, 14336
    buffer_load_dwordx2 v[18:19], v1, s[24:27], s31 offen
    buffer_load_dwordx4 v[20:23], v2, s[44:47], s15 offen
    buffer_load_dwordx4 v[24:27], v2, s[44:47], s15 offen offset:16
    v_and_b32 v33, 31, v0
    v_and_b32 v34, 3, v0
    v_lshrrev_b32 v2, 5, v0
    v_lshl_add_u32 v29, v2, 8, v33
    v_lshlrev_b32 v29, 3, v29
    v_mul_u32_u24 v3, 288, v2
    v_add_u32 v30, v3, v33
    v_lshlrev_b32 v30, 3, v30
    v_bfe_u32 v28, v0, 2, 3
    v_mul_u32_u24 v28, 36, v28
    v_add_u32 v3, v3, v28
    v_add_u32 v31, v3, v34
    v_lshlrev_b32 v31, 3, v31
    v_mul_u32_u24 v28, 9, v34
    v_add_u32 v32, v3, v28
    v_lshlrev_b32 v32, 3, v32
    v_cvt_f32_u32 v2, v0
    v_mul_f32 v28, 0x3a000000, v2
    v_fract_f32 v28, v28
    v_cos_f32 v3, v28
    v_sin_f32 v28, v28
    v_mul_f32 v36, 0x3a800000, v2
    v_fract_f32 v36, v36
    v_cos_f32 v35, v36
    v_sin_f32 v36, v36
    v_mul_f32 v38, 0x3ac00000, v2
    v_fract_f32 v38, v38
    v_cos_f32 v37, v38
    v_sin_f32 v38, v38
    v_mul_f32 v40, 0x3b000000, v2
    v_fract_f32 v40, v40
    v_cos_f32 v39, v40
    v_sin_f32 v40, v40
    v_mul_f32 v42, 0x3b200000, v2
    v_fract_f32 v42, v42
    v_cos_f32 v41, v42
    v_sin_f32 v42, v42
    v_mul_f32 v44, 0x3b400000, v2
    v_fract_f32 v44, v44
    v_cos_f32 v43, v44
    v_sin_f32 v44, v44
    v_mul_f32 v46, 0x3b600000, v2
    v_fract_f32 v46, v46
    v_cos_f32 v45, v46
    v_sin_f32 v46, v46
    v_cvt_f32_u32 v2, v33
    v_mul_f32 v48, 0x3b800000, v2
    v_fract_f32 v48, v48
    v_cos_f32 v47, v48
    v_sin_f32 v48, v48
    v_mul_f32 v50, 0x3c000000, v2
    v_fract_f32 v50, v50
    v_cos_f32 v49, v50
    v_sin_f32 v50, v50
    v_mul_f32 v52, 0x3c400000, v2
    v_fract_f32 v52, v52
    v_cos_f32 v51, v52
    v_sin_f32 v52, v52
    v_mul_f32 v54, 0x3c800000, v2
    v_fract_f32 v54, v54
    v_cos_f32 v53, v54
    v_sin_f32 v54, v54
    v_mul_f32 v56, 0x3ca00000, v2
    v_fract_f32 v56, v56
    v_cos_f32 v55, v56
    v_sin_f32 v56, v56
    v_mul_f32 v58, 0x3cc00000, v2
    v_fract_f32 v58, v58
    v_cos_f32 v57, v58
    v_sin_f32 v58, v58
    v_mul_f32 v60, 0x3ce00000, v2
    v_fract_f32 v60, v60
    v_cos_f32 v59, v60
    v_sin_f32 v60, v60
    v_cvt_f32_u32 v2, v34
    v_mul_f32 v62, 0x3d000000, v2
    v_fract_f32 v62, v62
    v_cos_f32 v61, v62
    v_sin_f32 v62, v62
    v_mul_f32 v64, 0x3d800000, v2
    v_fract_f32 v64, v64
    v_cos_f32 v63, v64
    v_sin_f32 v64, v64
    v_mul_f32 v66, 0x3dc00000, v2
    v_fract_f32 v66, v66
    v_cos_f32 v65, v66
    v_sin_f32 v66, v66
    v_mul_f32 v68, 0x3e000000, v2
    v_fract_f32 v68, v68
    v_cos_f32 v67, v68
    v_sin_f32 v68, v68
    v_mul_f32 v70, 0x3e200000, v2
    v_fract_f32 v70, v70
    v_cos_f32 v69, v70
    v_sin_f32 v70, v70
    v_mul_f32 v72, 0x3e400000, v2
    v_fract_f32 v72, v72
    v_cos_f32 v71, v72
    v_sin_f32 v72, v72
    v_mul_f32 v74, 0x3e600000, v2
    v_fract_f32 v74, v74
    v_cos_f32 v73, v74
    v_sin_f32 v74, v74
    s_waitcnt vmcnt(2)
    v_add_f32 v76, v4, v12
    v_add_f32 v77, v5, v13
    v_sub_f32 v78, v4, v12
    v_sub_f32 v79, v5, v13
    v_add_f32 v4, v6, v14
    v_add_f32 v5, v7, v15
    v_sub_f32 v12, v6, v14
    v_sub_f32 v13, v7, v15
    v_add_f32 v6, v8, v16
    v_add_f32 v7, v9, v17
    v_sub_f32 v14, v8, v16
    v_sub_f32 v15, v9, v17
    v_add_f32 v8, v10, v18
    v_add_f32 v9, v11, v19
    v_sub_f32 v16, v10, v18
    v_sub_f32 v17, v11, v19
    v_add_f32 v10, v12, v13
    v_sub_f32 v11, v13, v12
    v_sub_f32 v18, v17, v16
    v_add_f32 v19, v17, v16
    v_add_f32 v12, v76, v6
    v_add_f32 v13, v77, v7
    v_sub_f32 v16, v76, v6
    v_sub_f32 v17, v77, v7
    v_add_f32 v80, v4, v8
    v_add_f32 v81, v5, v9
    v_sub_f32 v82, v4, v8
    v_sub_f32 v83, v5, v9
    v_add_f32 v4, v78, v15
    v_sub_f32 v5, v79, v14
    v_sub_f32 v6, v78, v15
    v_add_f32 v7, v79, v14
    v_add_f32 v8, v10, v18
    v_sub_f32 v9, v11, v19
    v_sub_f32 v14, v10, v18
    v_add_f32 v15, v11, v19
    v_add_f32 v10, v12, v80
    v_add_f32 v11, v13, v81
    v_sub_f32 v18, v12, v80
    v_sub_f32 v19, v13, v81
    v_add_f32 v76, v16, v83
    v_sub_f32 v77, v17, v82
    v_sub_f32 v78, v16, v83
    v_add_f32 v79, v17, v82
    v_fma_f32 v84, v8, s30, v4
    v_fma_f32 v85, v9, s30, v5
    v_fma_f32 v86, -v8, s30, v4
    v_fma_f32 v87, -v9, s30, v5
    v_fma_f32 v88, v15, s30, v6
    v_fma_f32 v89, -v14, s30, v7
    v_fma_f32 v90, -v15, s30, v6
    v_fma_f32 v91, v14, s30, v7
    v_mul_f32_e64 v4, v84, v3
    v_mul_f32_e64 v5, v84, -v28
    v_fma_f32 v4, -v85, -v28, v4
    v_fma_f32 v5, v85, v3, v5
    v_mul_f32_e64 v6, v76, v35
    v_mul_f32_e64 v7, v76, -v36
    v_fma_f32 v6, -v77, -v36, v6
    v_fma_f32 v7, v77, v35, v7
    v_mul_f32_e64 v8, v88, v37
    v_mul_f32_e64 v9, v88, -v38
    v_fma_f32 v8, -v89, -v38, v8
    v_fma_f32 v9, v89, v37, v9
    v_mul_f32_e64 v12, v18, v39
    v_mul_f32_e64 v13, v18, -v40
    v_fma_f32 v12, -v19, -v40, v12
    v_fma_f32 v13, v19, v39, v13
    v_mul_f32_e64 v14, v86, v41
    v_mul_f32_e64 v15, v86, -v42
    v_fma_f32 v14, -v87, -v42, v14
    v_fma_f32 v15, v87, v41, v15
    v_mul_f32_e64 v16, v78, v43
    v_mul_f32_e64 v17, v78, -v44
    v_fma_f32 v16, -v79, -v44, v16
    v_fma_f32 v17, v79, v43, v17
    v_mul_f32_e64 v18, v90, v45
    v_mul_f32_e64 v19, v90, -v46
    v_fma_f32 v18, -v91, -v46, v18
    v_fma_f32 v19, v91, v45, v19
    ds_write_b64 v1, v[10:11] offset:0
    ds_write_b64 v1, v[4:5] offset:2048
    ds_write_b64 v1, v[6:7] offset:4096
    ds_write_b64 v1, v[8:9] offset:6144
    ds_write_b64 v1, v[12:13] offset:8192
    ds_write_b64 v1, v[14:15] offset:10240
    ds_write_b64 v1, v[16:17] offset:12288
    ds_write_b64 v1, v[18:19] offset:14336
    s_waitcnt lgkmcnt(0)
    s_barrier
    ds_read_b64 v[4:5], v29 offset:0
    ds_read_b64 v[6:7], v29 offset:256
    ds_read_b64 v[8:9], v29 offset:512
    ds_read_b64 v[10:11], v29 offset:768
    ds_read_b64 v[12:13], v29 offset:1024
    ds_read_b64 v[14:15], v29 offset:1280
    ds_read_b64 v[16:17], v29 offset:1536
    ds_read_b64 v[18:19], v29 offset:1792
    s_waitcnt lgkmcnt(0)
    v_add_f32 v76, v4, v12
    v_add_f32 v77, v5, v13
    v_sub_f32 v78, v4, v12
    v_sub_f32 v79, v5, v13
    v_add_f32 v4, v6, v14
    v_add_f32 v5, v7, v15
    v_sub_f32 v12, v6, v14
    v_sub_f32 v13, v7, v15
    v_add_f32 v6, v8, v16
    v_add_f32 v7, v9, v17
    v_sub_f32 v14, v8, v16
    v_sub_f32 v15, v9, v17
    v_add_f32 v8, v10, v18
    v_add_f32 v9, v11, v19
    v_sub_f32 v16, v10, v18
    v_sub_f32 v17, v11, v19
    v_add_f32 v10, v12, v13
    v_sub_f32 v11, v13, v12
    v_sub_f32 v18, v17, v16
    v_add_f32 v19, v17, v16
    v_add_f32 v12, v76, v6
    v_add_f32 v13, v77, v7
    v_sub_f32 v16, v76, v6
    v_sub_f32 v17, v77, v7
    v_add_f32 v80, v4, v8
    v_add_f32 v81, v5, v9
    v_sub_f32 v82, v4, v8
    v_sub_f32 v83, v5, v9
    v_add_f32 v4, v78, v15
    v_sub_f32 v5, v79, v14
    v_sub_f32 v6, v78, v15
    v_add_f32 v7, v79, v14
    v_add_f32 v8, v10, v18
    v_sub_f32 v9, v11, v19
    v_sub_f32 v14, v10, v18
    v_add_f32 v15, v11, v19
    v_add_f32 v10, v12, v80
    v_add_f32 v11, v13, v81
    v_sub_f32 v18, v12, v80
    v_sub_f32 v19, v13, v81
    v_add_f32 v76, v16, v83
    v_sub_f32 v77, v17, v82
    v_sub_f32 v78, v16, v83
    v_add_f32 v79, v17, v82
    v_fma_f32 v84, v8, s30, v4
    v_fma_f32 v85, v9, s30, v5
    v_fma_f32 v86, -v8, s30, v4
    v_fma_f32 v87, -v9, s30, v5
    v_fma_f32 v88, v15, s30, v6
    v_fma_f32 v89, -v14, s30, v7
    v_fma_f32 v90, -v15, s30, v6
    v_fma_f32 v91, v14, s30, v7
    v_mul_f32_e64 v4, v84, v47
    v_mul_f32_e64 v5, v84, -v48
    v_fma_f32 v4, -v85, -v48, v4
    v_fma_f32 v5, v85, v47, v5
    v_mul_f32_e64 v6, v76, v49
    v_mul_f32_e64 v7, v76, -v50
    v_fma_f32 v6, -v77, -v50, v6
    v_fma_f32 v7, v77, v49, v7
    v_mul_f32_e64 v8, v88, v51
    v_mul_f32_e64 v9, v88, -v52
    v_fma_f32 v8, -v89, -v52, v8
    v_fma_f32 v9, v89, v51, v9
    v_mul_f32_e64 v12, v18, v53
    v_mul_f32_e64 v13, v18, -v54
    v_fma_f32 v12, -v19, -v54, v12
    v_fma_f32 v13, v19, v53, v13
    v_mul_f32_e64 v14, v86, v55
    v_mul_f32_e64 v15, v86, -v56
    v_fma_f32 v14, -v87, -v56, v14
    v_fma_f32 v15, v87, v55, v15
    v_mul_f32_e64 v16, v78, v57
    v_mul_f32_e64 v17, v78, -v58
    v_fma_f32 v16, -v79, -v58, v16
    v_fma_f32 v17, v79, v57, v17
    v_mul_f32_e64 v18, v90, v59
    v_mul_f32_e64 v19, v90, -v60
    v_fma_f32 v18, -v91, -v60, v18
    v_fma_f32 v19, v91, v59, v19
    ds_write_b64 v30, v[10:11] offset:16384
    ds_write_b64 v30, v[4:5] offset:16672
    ds_write_b64 v30, v[6:7] offset:16960
    ds_write_b64 v30, v[8:9] offset:17248
    ds_write_b64 v30, v[12:13] offset:17536
    ds_write_b64 v30, v[14:15] offset:17824
    ds_write_b64 v30, v[16:17] offset:18112
    ds_write_b64 v30, v[18:19] offset:18400
    s_waitcnt lgkmcnt(0)
    ds_read_b64 v[4:5], v31 offset:16384
    ds_read_b64 v[6:7], v31 offset:16416
    ds_read_b64 v[8:9], v31 offset:16448
    ds_read_b64 v[10:11], v31 offset:16480
    ds_read_b64 v[12:13], v31 offset:16512
    ds_read_b64 v[14:15], v31 offset:16544
    ds_read_b64 v[16:17], v31 offset:16576
    ds_read_b64 v[18:19], v31 offset:16608
    s_waitcnt lgkmcnt(0)
    v_add_f32 v76, v4, v12
    v_add_f32 v77, v5, v13
    v_sub_f32 v78, v4, v12
    v_sub_f32 v79, v5, v13
    v_add_f32 v4, v6, v14
    v_add_f32 v5, v7, v15
    v_sub_f32 v12, v6, v14
    v_sub_f32 v13, v7, v15
    v_add_f32 v6, v8, v16
    v_add_f32 v7, v9, v17
    v_sub_f32 v14, v8, v16
    v_sub_f32 v15, v9, v17
    v_add_f32 v8, v10, v18
    v_add_f32 v9, v11, v19
    v_sub_f32 v16, v10, v18
    v_sub_f32 v17, v11, v19
    v_add_f32 v10, v12, v13
    v_sub_f32 v11, v13, v12
    v_sub_f32 v18, v17, v16
    v_add_f32 v19, v17, v16
    v_add_f32 v12, v76, v6
    v_add_f32 v13, v77, v7
    v_sub_f32 v16, v76, v6
    v_sub_f32 v17, v77, v7
    v_add_f32 v80, v4, v8
    v_add_f32 v81, v5, v9
    v_sub_f32 v82, v4, v8
    v_sub_f32 v83, v5, v9
    v_add_f32 v4, v78, v15
    v_sub_f32 v5, v79, v14
    v_sub_f32 v6, v78, v15
    v_add_f32 v7, v79, v14
    v_add_f32 v8, v10, v18
    v_sub_f32 v9, v11, v19
    v_sub_f32 v14, v10, v18
    v_add_f32 v15, v11, v19
    v_add_f32 v10, v12, v80
    v_add_f32 v11, v13, v81
    v_sub_f32 v18, v12, v80
    v_sub_f32 v19, v13, v81
    v_add_f32 v76, v16, v83
    v_sub_f32 v77, v17, v82
    v_sub_f32 v78, v16, v83
    v_add_f32 v79, v17, v82
    v_fma_f32 v84, v8, s30, v4
    v_fma_f32 v85, v9, s30, v5
    v_fma_f32 v86, -v8, s30, v4
    v_fma_f32 v87, -v9, s30, v5
    v_fma_f32 v88, v15, s30, v6
    v_fma_f32 v89, -v14, s30, v7
    v_fma_f32 v90, -v15, s30, v6
    v_fma_f32 v91, v14, s30, v7
    v_mul_f32_e64 v4, v84, v61
    v_mul_f32_e64 v5, v84, -v62
    v_fma_f32 v4, -v85, -v62, v4
    v_fma_f32 v5, v85, v61, v5
    v_mul_f32_e64 v6, v76, v63
    v_mul_f32_e64 v7, v76, -v64
    v_fma_f32 v6, -v77, -v64, v6
    v_fma_f32 v7, v77, v63, v7
    v_mul_f32_e64 v8, v88, v65
    v_mul_f32_e64 v9, v88, -v66
    v_fma_f32 v8, -v89, -v66, v8
    v_fma_f32 v9, v89, v65, v9
    v_mul_f32_e64 v12, v18, v67
    v_mul_f32_e64 v13, v18, -v68
    v_fma_f32 v12, -v19, -v68, v12
    v_fma_f32 v13, v19, v67, v13
    v_mul_f32_e64 v14, v86, v69
    v_mul_f32_e64 v15, v86, -v70
    v_fma_f32 v14, -v87, -v70, v14
    v_fma_f32 v15, v87, v69, v15
    v_mul_f32_e64 v16, v78, v71
    v_mul_f32_e64 v17, v78, -v72
    v_fma_f32 v16, -v79, -v72, v16
    v_fma_f32 v17, v79, v71, v17
    v_mul_f32_e64 v18, v90, v73
    v_mul_f32_e64 v19, v90, -v74
    v_fma_f32 v18, -v91, -v74, v18
    v_fma_f32 v19, v91, v73, v19
    ds_write_b64 v32, v[10:11] offset:16384
    ds_write_b64 v32, v[4:5] offset:16392
    ds_write_b64 v32, v[6:7] offset:16400
    ds_write_b64 v32, v[8:9] offset:16408
    ds_write_b64 v32, v[12:13] offset:16416
    ds_write_b64 v32, v[14:15] offset:16424
    ds_write_b64 v32, v[16:17] offset:16432
    ds_write_b64 v32, v[18:19] offset:16440
    s_waitcnt lgkmcnt(0)
    ds_read_b64 v[4:5], v31 offset:16384
    ds_read_b64 v[6:7], v31 offset:16456
    ds_read_b64 v[8:9], v31 offset:16528
    ds_read_b64 v[10:11], v31 offset:16600
    ds_read_b64 v[12:13], v31 offset:16416
    ds_read_b64 v[14:15], v31 offset:16488
    ds_read_b64 v[16:17], v31 offset:16560
    ds_read_b64 v[18:19], v31 offset:16632
    s_waitcnt lgkmcnt(0)
    v_add_f32 v76, v4, v8
    v_add_f32 v77, v5, v9
    v_sub_f32 v78, v4, v8
    v_sub_f32 v79, v5, v9
    v_add_f32 v80, v6, v10
    v_add_f32 v81, v7, v11
    v_sub_f32 v82, v6, v10
    v_sub_f32 v83, v7, v11
    v_add_f32 v4, v76, v80
    v_add_f32 v5, v77, v81
    v_sub_f32 v6, v76, v80
    v_sub_f32 v7, v77, v81
    v_add_f32 v8, v78, v83
    v_sub_f32 v9, v79, v82
    v_sub_f32 v10, v78, v83
    v_add_f32 v11, v79, v82
    v_add_f32 v76, v12, v16
    v_add_f32 v77, v13, v17
    v_sub_f32 v78, v12, v16
    v_sub_f32 v79, v13, v17
    v_add_f32 v80, v14, v18
    v_add_f32 v81, v15, v19
    v_sub_f32 v82, v14, v18
    v_sub_f32 v83, v15, v19
    v_add_f32 v12, v76, v80
    v_add_f32 v13, v77, v81
    v_sub_f32 v14, v76, v80
    v_sub_f32 v15, v77, v81
    v_add_f32 v16, v78, v83
    v_sub_f32 v17, v79, v82
    v_sub_f32 v18, v78, v83
    v_add_f32 v19, v79, v82
    s_waitcnt vmcnt(0)
    v_lshlrev_b32 v2, 16, v20
    v_and_b32 v33, 0xffff0000, v20
    v_mul_f32 v2, 0x35000000, v2
    v_mul_f32 v33, 0x35000000, v33
    v_mul_f32_e64 v76, v4, v2
    v_mul_f32_e64 v77, v4, v33
    v_fma_f32 v76, -v5, v33, v76
    v_fma_f32 v77, v5, v2, v77
    v_lshlrev_b32 v2, 16, v21
    v_and_b32 v33, 0xffff0000, v21
    v_mul_f32 v2, 0x35000000, v2
    v_mul_f32 v33, 0x35000000, v33
    v_mul_f32_e64 v4, v8, v2
    v_mul_f32_e64 v5, v8, v33
    v_fma_f32 v4, -v9, v33, v4
    v_fma_f32 v5, v9, v2, v5
    v_lshlrev_b32 v2, 16, v22
    v_and_b32 v33, 0xffff0000, v22
    v_mul_f32 v2, 0x35000000, v2
    v_mul_f32 v33, 0x35000000, v33
    v_mul_f32_e64 v8, v6, v2
    v_mul_f32_e64 v9, v6, v33
    v_fma_f32 v8, -v7, v33, v8
    v_fma_f32 v9, v7, v2, v9
    v_lshlrev_b32 v2, 16, v23
    v_and_b32 v33, 0xffff0000, v23
    v_mul_f32 v2, 0x35000000, v2
    v_mul_f32 v33, 0x35000000, v33
    v_mul_f32_e64 v6, v10, v2
    v_mul_f32_e64 v7, v10, v33
    v_fma_f32 v6, -v11, v33, v6
    v_fma_f32 v7, v11, v2, v7
    v_lshlrev_b32 v2, 16, v24
    v_and_b32 v33, 0xffff0000, v24
    v_mul_f32 v2, 0x35000000, v2
    v_mul_f32 v33, 0x35000000, v33
    v_mul_f32_e64 v10, v12, v2
    v_mul_f32_e64 v11, v12, v33
    v_fma_f32 v10, -v13, v33, v10
    v_fma_f32 v11, v13, v2, v11
    v_lshlrev_b32 v2, 16, v25
    v_and_b32 v33, 0xffff0000, v25
    v_mul_f32 v2, 0x35000000, v2
    v_mul_f32 v33, 0x35000000, v33
    v_mul_f32_e64 v12, v16, v2
    v_mul_f32_e64 v13, v16, v33
    v_fma_f32 v12, -v17, v33, v12
    v_fma_f32 v13, v17, v2, v13
    v_lshlrev_b32 v2, 16, v26
    v_and_b32 v33, 0xffff0000, v26
    v_mul_f32 v2, 0x35000000, v2
    v_mul_f32 v33, 0x35000000, v33
    v_mul_f32_e64 v16, v14, v2
    v_mul_f32_e64 v17, v14, v33
    v_fma_f32 v16, -v15, v33, v16
    v_fma_f32 v17, v15, v2, v17
    v_lshlrev_b32 v2, 16, v27
    v_and_b32 v33, 0xffff0000, v27
    v_mul_f32 v2, 0x35000000, v2
    v_mul_f32 v33, 0x35000000, v33
    v_mul_f32_e64 v14, v18, v2
    v_mul_f32_e64 v15, v18, v33
    v_fma_f32 v14, -v19, v33, v14
    v_fma_f32 v15, v19, v2, v15
    v_add_f32 v18, v76, v8
    v_add_f32 v19, v77, v9
    v_sub_f32 v20, v76, v8
    v_sub_f32 v21, v77, v9
    v_add_f32 v22, v4, v6
    v_add_f32 v23, v5, v7
    v_sub_f32 v24, v4, v6
    v_sub_f32 v25, v5, v7
    v_add_f32 v4, v18, v22
    v_add_f32 v5, v19, v23
    v_sub_f32 v6, v18, v22
    v_sub_f32 v7, v19, v23
    v_sub_f32 v8, v20, v25
    v_add_f32 v9, v21, v24
    v_add_f32 v26, v20, v25
    v_sub_f32 v27, v21, v24
    v_add_f32 v18, v10, v16
    v_add_f32 v19, v11, v17
    v_sub_f32 v20, v10, v16
    v_sub_f32 v21, v11, v17
    v_add_f32 v22, v12, v14
    v_add_f32 v23, v13, v15
    v_sub_f32 v24, v12, v14
    v_sub_f32 v25, v13, v15
    v_add_f32 v10, v18, v22
    v_add_f32 v11, v19, v23
    v_sub_f32 v12, v18, v22
    v_sub_f32 v13, v19, v23
    v_sub_f32 v14, v20, v25
    v_add_f32 v15, v21, v24
    v_add_f32 v16, v20, v25
    v_sub_f32 v17, v21, v24
    ds_write_b64 v31, v[4:5] offset:16384
    ds_write_b64 v31, v[8:9] offset:16456
    ds_write_b64 v31, v[6:7] offset:16528
    ds_write_b64 v31, v[26:27] offset:16600
    ds_write_b64 v31, v[10:11] offset:16416
    ds_write_b64 v31, v[14:15] offset:16488
    ds_write_b64 v31, v[12:13] offset:16560
    ds_write_b64 v31, v[16:17] offset:16632
    s_waitcnt lgkmcnt(0)
    ds_read_b64 v[4:5], v32 offset:16384
    ds_read_b64 v[6:7], v32 offset:16392
    ds_read_b64 v[8:9], v32 offset:16400
    ds_read_b64 v[10:11], v32 offset:16408
    ds_read_b64 v[12:13], v32 offset:16416
    ds_read_b64 v[14:15], v32 offset:16424
    ds_read_b64 v[16:17], v32 offset:16432
    ds_read_b64 v[18:19], v32 offset:16440
    s_waitcnt lgkmcnt(0)
    v_mul_f32_e64 v20, v6, v61
    v_mul_f32_e64 v21, v6, v62
    v_fma_f32 v20, -v7, v62, v20
    v_fma_f32 v21, v7, v61, v21
    v_mul_f32_e64 v6, v8, v63
    v_mul_f32_e64 v7, v8, v64
    v_fma_f32 v6, -v9, v64, v6
    v_fma_f32 v7, v9, v63, v7
    v_mul_f32_e64 v8, v10, v65
    v_mul_f32_e64 v9, v10, v66
    v_fma_f32 v8, -v11, v66, v8
    v_fma_f32 v9, v11, v65, v9
    v_mul_f32_e64 v10, v12, v67
    v_mul_f32_e64 v11, v12, v68
    v_fma_f32 v10, -v13, v68, v10
    v_fma_f32 v11, v13, v67, v11
    v_mul_f32_e64 v12, v14, v69
    v_mul_f32_e64 v13, v14, v70
    v_fma_f32 v12, -v15, v70, v12
    v_fma_f32 v13, v15, v69, v13
    v_mul_f32_e64 v14, v16, v71
    v_mul_f32_e64 v15, v16, v72
    v_fma_f32 v14, -v17, v72, v14
    v_fma_f32 v15, v17, v71, v15
    v_mul_f32_e64 v16, v18, v73
    v_mul_f32_e64 v17, v18, v74
    v_fma_f32 v16, -v19, v74, v16
    v_fma_f32 v17, v19, v73, v17
    v_add_f32 v18, v4, v10
    v_add_f32 v19, v5, v11
    v_sub_f32 v22, v4, v10
    v_sub_f32 v23, v5, v11
    v_add_f32 v4, v20, v12
    v_add_f32 v5, v21, v13
    v_sub_f32 v10, v20, v12
    v_sub_f32 v11, v21, v13
    v_add_f32 v12, v6, v14
    v_add_f32 v13, v7, v15
    v_sub_f32 v20, v6, v14
    v_sub_f32 v21, v7, v15
    v_add_f32 v6, v8, v16
    v_add_f32 v7, v9, v17
    v_sub_f32 v14, v8, v16
    v_sub_f32 v15, v9, v17
    v_sub_f32 v8, v10, v11
    v_add_f32 v9, v11, v10
    v_add_f32 v16, v14, v15
    v_sub_f32 v17, v14, v15
    v_add_f32 v10, v18, v12
    v_add_f32 v11, v19, v13
    v_sub_f32 v14, v18, v12
    v_sub_f32 v15, v19, v13
    v_add_f32 v24, v4, v6
    v_add_f32 v25, v5, v7
    v_sub_f32 v26, v4, v6
    v_sub_f32 v27, v5, v7
    v_sub_f32 v4, v22, v21
    v_add_f32 v5, v23, v20
    v_add_f32 v6, v22, v21
    v_sub_f32 v7, v23, v20
    v_sub_f32 v12, v8, v16
    v_add_f32 v13, v9, v17
    v_add_f32 v18, v8, v16
    v_sub_f32 v19, v9, v17
    v_add_f32 v8, v10, v24
    v_add_f32 v9, v11, v25
    v_sub_f32 v16, v10, v24
    v_sub_f32 v17, v11, v25
    v_sub_f32 v20, v14, v27
    v_add_f32 v21, v15, v26
    v_add_f32 v22, v14, v27
    v_sub_f32 v23, v15, v26
    v_fma_f32 v76, v12, s30, v4
    v_fma_f32 v77, v13, s30, v5
    v_fma_f32 v78, -v12, s30, v4
    v_fma_f32 v79, -v13, s30, v5
    v_fma_f32 v80, -v19, s30, v6
    v_fma_f32 v81, v18, s30, v7
    v_fma_f32 v82, v19, s30, v6
    v_fma_f32 v83, -v18, s30, v7
    ds_write_b64 v31, v[8:9] offset:16384
    ds_write_b64 v31, v[76:77] offset:16416
    ds_write_b64 v31, v[20:21] offset:16448
    ds_write_b64 v31, v[80:81] offset:16480
    ds_write_b64 v31, v[16:17] offset:16512
    ds_write_b64 v31, v[78:79] offset:16544
    ds_write_b64 v31, v[22:23] offset:16576
    ds_write_b64 v31, v[82:83] offset:16608
    s_waitcnt lgkmcnt(0)
    ds_read_b64 v[4:5], v30 offset:16384
    ds_read_b64 v[6:7], v30 offset:16672
    ds_read_b64 v[8:9], v30 offset:16960
    ds_read_b64 v[10:11], v30 offset:17248
    ds_read_b64 v[12:13], v30 offset:17536
    ds_read_b64 v[14:15], v30 offset:17824
    ds_read_b64 v[16:17], v30 offset:18112
    ds_read_b64 v[18:19], v30 offset:18400
    s_waitcnt lgkmcnt(0)
    v_mul_f32_e64 v20, v6, v47
    v_mul_f32_e64 v21, v6, v48
    v_fma_f32 v20, -v7, v48, v20
    v_fma_f32 v21, v7, v47, v21
    v_mul_f32_e64 v6, v8, v49
    v_mul_f32_e64 v7, v8, v50
    v_fma_f32 v6, -v9, v50, v6
    v_fma_f32 v7, v9, v49, v7
    v_mul_f32_e64 v8, v10, v51
    v_mul_f32_e64 v9, v10, v52
    v_fma_f32 v8, -v11, v52, v8
    v_fma_f32 v9, v11, v51, v9
    v_mul_f32_e64 v10, v12, v53
    v_mul_f32_e64 v11, v12, v54
    v_fma_f32 v10, -v13, v54, v10
    v_fma_f32 v11, v13, v53, v11
    v_mul_f32_e64 v12, v14, v55
    v_mul_f32_e64 v13, v14, v56
    v_fma_f32 v12, -v15, v56, v12
    v_fma_f32 v13, v15, v55, v13
    v_mul_f32_e64 v14, v16, v57
    v_mul_f32_e64 v15, v16, v58
    v_fma_f32 v14, -v17, v58, v14
    v_fma_f32 v15, v17, v57, v15
    v_mul_f32_e64 v16, v18, v59
    v_mul_f32_e64 v17, v18, v60
    v_fma_f32 v16, -v19, v60, v16
    v_fma_f32 v17, v19, v59, v17
    v_add_f32 v18, v4, v10
    v_add_f32 v19, v5, v11
    v_sub_f32 v22, v4, v10
    v_sub_f32 v23, v5, v11
    v_add_f32 v4, v20, v12
    v_add_f32 v5, v21, v13
    v_sub_f32 v10, v20, v12
    v_sub_f32 v11, v21, v13
    v_add_f32 v12, v6, v14
    v_add_f32 v13, v7, v15
    v_sub_f32 v20, v6, v14
    v_sub_f32 v21, v7, v15
    v_add_f32 v6, v8, v16
    v_add_f32 v7, v9, v17
    v_sub_f32 v14, v8, v16
    v_sub_f32 v15, v9, v17
    v_sub_f32 v8, v10, v11
    v_add_f32 v9, v11, v10
    v_add_f32 v16, v14, v15
    v_sub_f32 v17, v14, v15
    v_add_f32 v10, v18, v12
    v_add_f32 v11, v19, v13
    v_sub_f32 v14, v18, v12
    v_sub_f32 v15, v19, v13
    v_add_f32 v24, v4, v6
    v_add_f32 v25, v5, v7
    v_sub_f32 v26, v4, v6
    v_sub_f32 v27, v5, v7
    v_sub_f32 v4, v22, v21
    v_add_f32 v5, v23, v20
    v_add_f32 v6, v22, v21
    v_sub_f32 v7, v23, v20
    v_sub_f32 v12, v8, v16
    v_add_f32 v13, v9, v17
    v_add_f32 v18, v8, v16
    v_sub_f32 v19, v9, v17
    v_add_f32 v8, v10, v24
    v_add_f32 v9, v11, v25
    v_sub_f32 v16, v10, v24
    v_sub_f32 v17, v11, v25
    v_sub_f32 v20, v14, v27
    v_add_f32 v21, v15, v26
    v_add_f32 v22, v14, v27
    v_sub_f32 v23, v15, v26
    v_fma_f32 v76, v12, s30, v4
    v_fma_f32 v77, v13, s30, v5
    v_fma_f32 v78, -v12, s30, v4
    v_fma_f32 v79, -v13, s30, v5
    v_fma_f32 v80, -v19, s30, v6
    v_fma_f32 v81, v18, s30, v7
    v_fma_f32 v82, v19, s30, v6
    v_fma_f32 v83, -v18, s30, v7
    ds_write_b64 v29, v[8:9] offset:34816
    ds_write_b64 v29, v[76:77] offset:35072
    ds_write_b64 v29, v[20:21] offset:35328
    ds_write_b64 v29, v[80:81] offset:35584
    ds_write_b64 v29, v[16:17] offset:35840
    ds_write_b64 v29, v[78:79] offset:36096
    ds_write_b64 v29, v[22:23] offset:36352
    ds_write_b64 v29, v[82:83] offset:36608
    s_waitcnt lgkmcnt(0)
    s_barrier
    ds_read_b64 v[4:5], v1 offset:34816
    ds_read_b64 v[6:7], v1 offset:36864
    ds_read_b64 v[8:9], v1 offset:38912
    ds_read_b64 v[10:11], v1 offset:40960
    ds_read_b64 v[12:13], v1 offset:43008
    ds_read_b64 v[14:15], v1 offset:45056
    ds_read_b64 v[16:17], v1 offset:47104
    ds_read_b64 v[18:19], v1 offset:49152
    s_waitcnt lgkmcnt(0)
    v_mul_f32_e64 v20, v6, v3
    v_mul_f32_e64 v21, v6, v28
    v_fma_f32 v20, -v7, v28, v20
    v_fma_f32 v21, v7, v3, v21
    v_mul_f32_e64 v6, v8, v35
    v_mul_f32_e64 v7, v8, v36
    v_fma_f32 v6, -v9, v36, v6
    v_fma_f32 v7, v9, v35, v7
    v_mul_f32_e64 v8, v10, v37
    v_mul_f32_e64 v9, v10, v38
    v_fma_f32 v8, -v11, v38, v8
    v_fma_f32 v9, v11, v37, v9
    v_mul_f32_e64 v10, v12, v39
    v_mul_f32_e64 v11, v12, v40
    v_fma_f32 v10, -v13, v40, v10
    v_fma_f32 v11, v13, v39, v11
    v_mul_f32_e64 v12, v14, v41
    v_mul_f32_e64 v13, v14, v42
    v_fma_f32 v12, -v15, v42, v12
    v_fma_f32 v13, v15, v41, v13
    v_mul_f32_e64 v14, v16, v43
    v_mul_f32_e64 v15, v16, v44
    v_fma_f32 v14, -v17, v44, v14
    v_fma_f32 v15, v17, v43, v15
    v_mul_f32_e64 v16, v18, v45
    v_mul_f32_e64 v17, v18, v46
    v_fma_f32 v16, -v19, v46, v16
    v_fma_f32 v17, v19, v45, v17
    v_add_f32 v18, v4, v10
    v_add_f32 v19, v5, v11
    v_sub_f32 v22, v4, v10
    v_sub_f32 v23, v5, v11
    v_add_f32 v4, v20, v12
    v_add_f32 v5, v21, v13
    v_sub_f32 v10, v20, v12
    v_sub_f32 v11, v21, v13
    v_add_f32 v12, v6, v14
    v_add_f32 v13, v7, v15
    v_sub_f32 v20, v6, v14
    v_sub_f32 v21, v7, v15
    v_add_f32 v6, v8, v16
    v_add_f32 v7, v9, v17
    v_sub_f32 v14, v8, v16
    v_sub_f32 v15, v9, v17
    v_sub_f32 v8, v10, v11
    v_add_f32 v9, v11, v10
    v_add_f32 v16, v14, v15
    v_sub_f32 v17, v14, v15
    v_add_f32 v10, v18, v12
    v_add_f32 v11, v19, v13
    v_sub_f32 v14, v18, v12
    v_sub_f32 v15, v19, v13
    v_add_f32 v24, v4, v6
    v_add_f32 v25, v5, v7
    v_sub_f32 v26, v4, v6
    v_sub_f32 v27, v5, v7
    v_sub_f32 v4, v22, v21
    v_add_f32 v5, v23, v20
    v_add_f32 v6, v22, v21
    v_sub_f32 v7, v23, v20
    v_sub_f32 v12, v8, v16
    v_add_f32 v13, v9, v17
    v_add_f32 v18, v8, v16
    v_sub_f32 v19, v9, v17
    v_add_f32 v8, v10, v24
    v_add_f32 v9, v11, v25
    v_sub_f32 v16, v10, v24
    v_sub_f32 v17, v11, v25
    v_sub_f32 v20, v14, v27
    v_add_f32 v21, v15, v26
    v_add_f32 v22, v14, v27
    v_sub_f32 v23, v15, v26
    v_fma_f32 v76, v12, s30, v4
    v_fma_f32 v77, v13, s30, v5
    v_fma_f32 v78, -v12, s30, v4
    v_fma_f32 v79, -v13, s30, v5
    v_fma_f32 v80, -v19, s30, v6
    v_fma_f32 v81, v18, s30, v7
    v_fma_f32 v82, v19, s30, v6
    v_fma_f32 v83, -v18, s30, v7
    s_add_u32 s31, s14, 0
    buffer_store_dwordx2 v[8:9], v1, s[24:27], s31 offen
    s_add_u32 s31, s14, 2048
    buffer_store_dwordx2 v[76:77], v1, s[24:27], s31 offen
    s_add_u32 s31, s14, 4096
    buffer_store_dwordx2 v[20:21], v1, s[24:27], s31 offen
    s_add_u32 s31, s14, 6144
    buffer_store_dwordx2 v[80:81], v1, s[24:27], s31 offen
    s_add_u32 s31, s14, 8192
    buffer_store_dwordx2 v[16:17], v1, s[24:27], s31 offen
    s_add_u32 s31, s14, 10240
    buffer_store_dwordx2 v[78:79], v1, s[24:27], s31 offen
    s_add_u32 s31, s14, 12288
    buffer_store_dwordx2 v[22:23], v1, s[24:27], s31 offen
    s_add_u32 s31, s14, 14336
    buffer_store_dwordx2 v[82:83], v1, s[24:27], s31 offen
    s_endpgm
K2_EXIT:
    s_endpgm
.globl k3_kernel
.p2align 8
.type k3_kernel,@function
k3_kernel:
    s_cmp_ge_u32 s2, 256
    s_cbranch_scc1 K3_EXIT
    s_and_b32 s31, s2, 7
    s_lshl_b32 s31, s31, 5
    s_lshr_b32 s2, s2, 3
    s_add_u32 s2, s2, s31
    s_load_dwordx2 s[4:5], s[0:1], 64
    s_load_dwordx2 s[12:13], s[0:1], 80
    s_mov_b32 s30, 0x3f3504f3
    v_and_b32 v1, 63, v0
    v_lshrrev_b32 v2, 6, v0
    s_nop 0
    v_readfirstlane_b32 s3, v2
    s_waitcnt lgkmcnt(0)
    s_mov_b32 s16, s4
    s_mov_b32 s17, s5
    s_mov_b32 s18, 0x200000
    s_mov_b32 s19, 0x00020000
    s_mov_b32 s24, s12
    s_mov_b32 s25, s13
    s_mov_b32 s26, 0x414100
    s_mov_b32 s27, 0x00020000
    s_add_u32 s20, s12, 0xd00000
    s_addc_u32 s21, s13, 0
    s_mov_b32 s22, 0x200000
    s_mov_b32 s23, 0x00020000
    s_lshl_b32 s14, s2, 3
    s_lshl_b32 s15, s3, 1
    s_add_u32 s14, s14, s15
    s_lshl_b32 s15, s14, 10
    s_add_u32 s28, s15, 1024
    s_add_u32 s32, s12, 0xf00000
    s_addc_u32 s33, s13, 0
    s_mov_b32 s34, 0x2000
    s_mov_b32 s35, 0x00020000
    v_mov_b32 v4, 0
    s_lshl_b32 s31, s14, 2
    buffer_load_dwordx2 v[4:5], v4, s[32:35], s31 offen
    v_and_b32 v3, 3, v0
    v_lshrrev_b32 v6, 2, v0
    v_mul_u32_u24 v9, 16640, v6
    v_lshl_add_u32 v9, v3, 4, v9
    s_lshl_b32 s29, s2, 6
    s_add_u32 s31, s29, 0x0
    buffer_load_dwordx4 v[12:15], v9, s[24:27], s31 offen
    s_add_u32 s31, s29, 0x104000
    buffer_load_dwordx4 v[16:19], v9, s[24:27], s31 offen
    s_add_u32 s31, s29, 0x208000
    buffer_load_dwordx4 v[20:23], v9, s[24:27], s31 offen
    s_add_u32 s31, s29, 0x30c000
    buffer_load_dwordx4 v[24:27], v9, s[24:27], s31 offen
    s_add_u32 s31, s29, 0x410000
    buffer_load_dwordx4 v[28:31], v9, s[24:27], s31 offen
    v_mul_u32_u24 v7, 520, v3
    v_sub_u32 v8, v7, v6
    v_add_u32 v7, v7, v6
    v_lshlrev_b32 v7, 3, v7
    v_add_u32 v8, 256, v8
    v_lshlrev_b32 v8, 3, v8
    v_lshlrev_b32 v10, 4, v1
    buffer_load_dwordx4 v[32:35], v10, s[20:23], s15 offen
    buffer_load_dwordx4 v[36:39], v10, s[20:23], s28 offen
    v_mul_u32_u24 v11, 4608, v2
    v_lshl_add_u32 v40, v1, 3, v11
    v_lshrrev_b32 v43, 3, v1
    v_and_b32 v44, 7, v1
    v_mul_u32_u24 v43, 72, v43
    v_add_u32 v41, v43, v44
    v_lshl_add_u32 v41, v41, 3, v11
    v_mul_u32_u24 v42, 9, v44
    v_add_u32 v42, v42, v43
    v_lshl_add_u32 v42, v42, 3, v11
    v_cvt_f32_u32 v45, v1
    v_mul_f32 v47, 0x3b000000, v45
    v_fract_f32 v47, v47
    v_cos_f32 v46, v47
    v_sin_f32 v47, v47
    v_mul_f32 v49, 0x3b800000, v45
    v_fract_f32 v49, v49
    v_cos_f32 v48, v49
    v_sin_f32 v49, v49
    v_mul_f32 v51, 0x3bc00000, v45
    v_fract_f32 v51, v51
    v_cos_f32 v50, v51
    v_sin_f32 v51, v51
    v_mul_f32 v53, 0x3c000000, v45
    v_fract_f32 v53, v53
    v_cos_f32 v52, v53
    v_sin_f32 v53, v53
    v_mul_f32 v55, 0x3c200000, v45
    v_fract_f32 v55, v55
    v_cos_f32 v54, v55
    v_sin_f32 v55, v55
    v_mul_f32 v57, 0x3c400000, v45
    v_fract_f32 v57, v57
    v_cos_f32 v56, v57
    v_sin_f32 v57, v57
    v_mul_f32 v59, 0x3c600000, v45
    v_fract_f32 v59, v59
    v_cos_f32 v58, v59
    v_sin_f32 v59, v59
    v_cvt_f32_u32 v45, v44
    v_mul_f32 v61, 0x3c800000, v45
    v_fract_f32 v61, v61
    v_cos_f32 v60, v61
    v_sin_f32 v61, v61
    v_mul_f32 v63, 0x3d000000, v45
    v_fract_f32 v63, v63
    v_cos_f32 v62, v63
    v_sin_f32 v63, v63
    v_mul_f32 v65, 0x3d400000, v45
    v_fract_f32 v65, v65
    v_cos_f32 v64, v65
    v_sin_f32 v65, v65
    v_mul_f32 v67, 0x3d800000, v45
    v_fract_f32 v67, v67
    v_cos_f32 v66, v67
    v_sin_f32 v67, v67
    v_mul_f32 v69, 0x3da00000, v45
    v_fract_f32 v69, v69
    v_cos_f32 v68, v69
    v_sin_f32 v69, v69
    v_mul_f32 v71, 0x3dc00000, v45
    v_fract_f32 v71, v71
    v_cos_f32 v70, v71
    v_sin_f32 v71, v71
    v_mul_f32 v73, 0x3de00000, v45
    v_fract_f32 v73, v73
    v_cos_f32 v72, v73
    v_sin_f32 v73, v73
    v_mul_u32_u24 v43, 520, v2
    v_add_u32 v43, v43, v1
    v_lshlrev_b32 v43, 3, v43
    v_cmp_eq_u32 vcc, 0, v6
    s_waitcnt vmcnt(6)
    s_nop 0
    v_cndmask_b32_e64 v13, v13, 0, vcc
    v_cndmask_b32_e64 v15, v15, 0, vcc
    v_sub_f32 v44, v12, v15
    v_add_f32 v45, v13, v14
    v_add_f32 v74, v12, v15
    v_sub_f32 v75, v14, v13
    ds_write_b64 v7, v[44:45] offset:18432
    ds_write_b64 v8, v[74:75] offset:20480
    s_waitcnt vmcnt(5)
    v_sub_f32 v44, v16, v19
    v_add_f32 v45, v17, v18
    v_add_f32 v74, v16, v19
    v_sub_f32 v75, v18, v17
    ds_write_b64 v7, v[44:45] offset:18944
    ds_write_b64 v8, v[74:75] offset:19968
    s_waitcnt vmcnt(4)
    v_sub_f32 v44, v20, v23
    v_add_f32 v45, v21, v22
    v_add_f32 v74, v20, v23
    v_sub_f32 v75, v22, v21
    ds_write_b64 v7, v[44:45] offset:19456
    ds_write_b64 v8, v[74:75] offset:19456
    s_waitcnt vmcnt(3)
    v_sub_f32 v44, v24, v27
    v_add_f32 v45, v25, v26
    v_add_f32 v74, v24, v27
    v_sub_f32 v75, v26, v25
    ds_write_b64 v7, v[44:45] offset:19968
    ds_write_b64 v8, v[74:75] offset:18944
    s_waitcnt vmcnt(2)
    v_cmp_gt_u32 vcc, 4, v0
    s_nop 0
    s_and_saveexec_b64 s[48:49], vcc
    s_cbranch_execz K3I256_12
    v_mov_b32 v44, v28
    v_mov_b32 v45, v30
    ds_write_b64 v7, v[44:45] offset:20480
K3I256_12:
    s_mov_b64 exec, -1
    s_waitcnt lgkmcnt(0)
    s_barrier
    ds_read_b64 v[6:7], v43 offset:18432
    ds_read_b64 v[8:9], v43 offset:18944
    ds_read_b64 v[12:13], v43 offset:19456
    ds_read_b64 v[14:15], v43 offset:19968
    ds_read_b64 v[16:17], v43 offset:20480
    ds_read_b64 v[18:19], v43 offset:20992
    ds_read_b64 v[20:21], v43 offset:21504
    ds_read_b64 v[22:23], v43 offset:22016
    s_waitcnt lgkmcnt(0)
    v_add_f32 v24, v6, v16
    v_add_f32 v25, v7, v17
    v_sub_f32 v26, v6, v16
    v_sub_f32 v27, v7, v17
    v_add_f32 v6, v8, v18
    v_add_f32 v7, v9, v19
    v_sub_f32 v16, v8, v18
    v_sub_f32 v17, v9, v19
    v_add_f32 v8, v12, v20
    v_add_f32 v9, v13, v21
    v_sub_f32 v18, v12, v20
    v_sub_f32 v19, v13, v21
    v_add_f32 v12, v14, v22
    v_add_f32 v13, v15, v23
    v_sub_f32 v20, v14, v22
    v_sub_f32 v21, v15, v23
    v_sub_f32 v14, v16, v17
    v_add_f32 v15, v17, v16
    v_add_f32 v22, v20, v21
    v_sub_f32 v23, v20, v21
    v_add_f32 v16, v24, v8
    v_add_f32 v17, v25, v9
    v_sub_f32 v20, v24, v8
    v_sub_f32 v21, v25, v9
    v_add_f32 v28, v6, v12
    v_add_f32 v29, v7, v13
    v_sub_f32 v30, v6, v12
    v_sub_f32 v31, v7, v13
    v_sub_f32 v6, v26, v19
    v_add_f32 v7, v27, v18
    v_add_f32 v8, v26, v19
    v_sub_f32 v9, v27, v18
    v_sub_f32 v12, v14, v22
    v_add_f32 v13, v15, v23
    v_add_f32 v18, v14, v22
    v_sub_f32 v19, v15, v23
    v_add_f32 v14, v16, v28
    v_add_f32 v15, v17, v29
    v_sub_f32 v22, v16, v28
    v_sub_f32 v23, v17, v29
    v_sub_f32 v24, v20, v31
    v_add_f32 v25, v21, v30
    v_add_f32 v26, v20, v31
    v_sub_f32 v27, v21, v30
    v_fma_f32 v44, v12, s30, v6
    v_fma_f32 v45, v13, s30, v7
    v_fma_f32 v74, -v12, s30, v6
    v_fma_f32 v75, -v13, s30, v7
    v_fma_f32 v76, -v19, s30, v8
    v_fma_f32 v77, v18, s30, v9
    v_fma_f32 v78, v19, s30, v8
    v_fma_f32 v79, -v18, s30, v9
    ds_write_b64 v40, v[14:15] offset:0
    v_mul_f32_e64 v6, v44, v46
    v_mul_f32_e64 v7, v44, v47
    v_fma_f32 v6, -v45, v47, v6
    v_fma_f32 v7, v45, v46, v7
    ds_write_b64 v40, v[6:7] offset:576
    v_mul_f32_e64 v6, v24, v48
    v_mul_f32_e64 v7, v24, v49
    v_fma_f32 v6, -v25, v49, v6
    v_fma_f32 v7, v25, v48, v7
    ds_write_b64 v40, v[6:7] offset:1152
    v_mul_f32_e64 v6, v76, v50
    v_mul_f32_e64 v7, v76, v51
    v_fma_f32 v6, -v77, v51, v6
    v_fma_f32 v7, v77, v50, v7
    ds_write_b64 v40, v[6:7] offset:1728
    v_mul_f32_e64 v6, v22, v52
    v_mul_f32_e64 v7, v22, v53
    v_fma_f32 v6, -v23, v53, v6
    v_fma_f32 v7, v23, v52, v7
    ds_write_b64 v40, v[6:7] offset:2304
    v_mul_f32_e64 v6, v74, v54
    v_mul_f32_e64 v7, v74, v55
    v_fma_f32 v6, -v75, v55, v6
    v_fma_f32 v7, v75, v54, v7
    ds_write_b64 v40, v[6:7] offset:2880
    v_mul_f32_e64 v6, v26, v56
    v_mul_f32_e64 v7, v26, v57
    v_fma_f32 v6, -v27, v57, v6
    v_fma_f32 v7, v27, v56, v7
    ds_write_b64 v40, v[6:7] offset:3456
    v_mul_f32_e64 v6, v78, v58
    v_mul_f32_e64 v7, v78, v59
    v_fma_f32 v6, -v79, v59, v6
    v_fma_f32 v7, v79, v58, v7
    ds_write_b64 v40, v[6:7] offset:4032
    s_waitcnt lgkmcnt(0)
    ds_read_b64 v[6:7], v41 offset:0
    ds_read_b64 v[8:9], v41 offset:64
    ds_read_b64 v[12:13], v41 offset:128
    ds_read_b64 v[14:15], v41 offset:192
    ds_read_b64 v[16:17], v41 offset:256
    ds_read_b64 v[18:19], v41 offset:320
    ds_read_b64 v[20:21], v41 offset:384
    ds_read_b64 v[22:23], v41 offset:448
    s_waitcnt lgkmcnt(0)
    v_add_f32 v24, v6, v16
    v_add_f32 v25, v7, v17
    v_sub_f32 v26, v6, v16
    v_sub_f32 v27, v7, v17
    v_add_f32 v6, v8, v18
    v_add_f32 v7, v9, v19
    v_sub_f32 v16, v8, v18
    v_sub_f32 v17, v9, v19
    v_add_f32 v8, v12, v20
    v_add_f32 v9, v13, v21
    v_sub_f32 v18, v12, v20
    v_sub_f32 v19, v13, v21
    v_add_f32 v12, v14, v22
    v_add_f32 v13, v15, v23
    v_sub_f32 v20, v14, v22
    v_sub_f32 v21, v15, v23
    v_sub_f32 v14, v16, v17
    v_add_f32 v15, v17, v16
    v_add_f32 v22, v20, v21
    v_sub_f32 v23, v20, v21
    v_add_f32 v16, v24, v8
    v_add_f32 v17, v25, v9
    v_sub_f32 v20, v24, v8
    v_sub_f32 v21, v25, v9
    v_add_f32 v28, v6, v12
    v_add_f32 v29, v7, v13
    v_sub_f32 v30, v6, v12
    v_sub_f32 v31, v7, v13
    v_sub_f32 v6, v26, v19
    v_add_f32 v7, v27, v18
    v_add_f32 v8, v26, v19
    v_sub_f32 v9, v27, v18
    v_sub_f32 v12, v14, v22
    v_add_f32 v13, v15, v23
    v_add_f32 v18, v14, v22
    v_sub_f32 v19, v15, v23
    v_add_f32 v14, v16, v28
    v_add_f32 v15, v17, v29
    v_sub_f32 v22, v16, v28
    v_sub_f32 v23, v17, v29
    v_sub_f32 v24, v20, v31
    v_add_f32 v25, v21, v30
    v_add_f32 v26, v20, v31
    v_sub_f32 v27, v21, v30
    v_fma_f32 v44, v12, s30, v6
    v_fma_f32 v45, v13, s30, v7
    v_fma_f32 v46, -v12, s30, v6
    v_fma_f32 v47, -v13, s30, v7
    v_fma_f32 v48, -v19, s30, v8
    v_fma_f32 v49, v18, s30, v9
    v_fma_f32 v50, v19, s30, v8
    v_fma_f32 v51, -v18, s30, v9
    ds_write_b64 v41, v[14:15] offset:0
    v_mul_f32_e64 v6, v44, v60
    v_mul_f32_e64 v7, v44, v61
    v_fma_f32 v6, -v45, v61, v6
    v_fma_f32 v7, v45, v60, v7
    ds_write_b64 v41, v[6:7] offset:72
    v_mul_f32_e64 v6, v24, v62
    v_mul_f32_e64 v7, v24, v63
    v_fma_f32 v6, -v25, v63, v6
    v_fma_f32 v7, v25, v62, v7
    ds_write_b64 v41, v[6:7] offset:144
    v_mul_f32_e64 v6, v48, v64
    v_mul_f32_e64 v7, v48, v65
    v_fma_f32 v6, -v49, v65, v6
    v_fma_f32 v7, v49, v64, v7
    ds_write_b64 v41, v[6:7] offset:216
    v_mul_f32_e64 v6, v22, v66
    v_mul_f32_e64 v7, v22, v67
    v_fma_f32 v6, -v23, v67, v6
    v_fma_f32 v7, v23, v66, v7
    ds_write_b64 v41, v[6:7] offset:288
    v_mul_f32_e64 v6, v46, v68
    v_mul_f32_e64 v7, v46, v69
    v_fma_f32 v6, -v47, v69, v6
    v_fma_f32 v7, v47, v68, v7
    ds_write_b64 v41, v[6:7] offset:360
    v_mul_f32_e64 v6, v26, v70
    v_mul_f32_e64 v7, v26, v71
    v_fma_f32 v6, -v27, v71, v6
    v_fma_f32 v7, v27, v70, v7
    ds_write_b64 v41, v[6:7] offset:432
    v_mul_f32_e64 v6, v50, v72
    v_mul_f32_e64 v7, v50, v73
    v_fma_f32 v6, -v51, v73, v6
    v_fma_f32 v7, v51, v72, v7
    ds_write_b64 v41, v[6:7] offset:504
    s_waitcnt lgkmcnt(0)
    ds_read_b64 v[6:7], v42 offset:0
    ds_read_b64 v[8:9], v42 offset:8
    ds_read_b64 v[12:13], v42 offset:16
    ds_read_b64 v[14:15], v42 offset:24
    ds_read_b64 v[16:17], v42 offset:32
    ds_read_b64 v[18:19], v42 offset:40
    ds_read_b64 v[20:21], v42 offset:48
    ds_read_b64 v[22:23], v42 offset:56
    s_waitcnt lgkmcnt(0)
    v_add_f32 v24, v6, v16
    v_add_f32 v25, v7, v17
    v_sub_f32 v26, v6, v16
    v_sub_f32 v27, v7, v17
    v_add_f32 v6, v8, v18
    v_add_f32 v7, v9, v19
    v_sub_f32 v16, v8, v18
    v_sub_f32 v17, v9, v19
    v_add_f32 v8, v12, v20
    v_add_f32 v9, v13, v21
    v_sub_f32 v18, v12, v20
    v_sub_f32 v19, v13, v21
    v_add_f32 v12, v14, v22
    v_add_f32 v13, v15, v23
    v_sub_f32 v20, v14, v22
    v_sub_f32 v21, v15, v23
    v_sub_f32 v14, v16, v17
    v_add_f32 v15, v17, v16
    v_add_f32 v22, v20, v21
    v_sub_f32 v23, v20, v21
    v_add_f32 v16, v24, v8
    v_add_f32 v17, v25, v9
    v_sub_f32 v20, v24, v8
    v_sub_f32 v21, v25, v9
    v_add_f32 v28, v6, v12
    v_add_f32 v29, v7, v13
    v_sub_f32 v30, v6, v12
    v_sub_f32 v31, v7, v13
    v_sub_f32 v6, v26, v19
    v_add_f32 v7, v27, v18
    v_add_f32 v8, v26, v19
    v_sub_f32 v9, v27, v18
    v_sub_f32 v12, v14, v22
    v_add_f32 v13, v15, v23
    v_add_f32 v18, v14, v22
    v_sub_f32 v19, v15, v23
    v_add_f32 v14, v16, v28
    v_add_f32 v15, v17, v29
    v_sub_f32 v22, v16, v28
    v_sub_f32 v23, v17, v29
    v_sub_f32 v24, v20, v31
    v_add_f32 v25, v21, v30
    v_add_f32 v26, v20, v31
    v_sub_f32 v27, v21, v30
    v_fma_f32 v44, v12, s30, v6
    v_fma_f32 v45, v13, s30, v7
    v_fma_f32 v46, -v12, s30, v6
    v_fma_f32 v47, -v13, s30, v7
    v_fma_f32 v48, -v19, s30, v8
    v_fma_f32 v49, v18, s30, v9
    v_fma_f32 v50, v19, s30, v8
    v_fma_f32 v51, -v18, s30, v9
    v_lshrrev_b32 v3, 3, v1
    v_and_b32 v6, 7, v1
    v_lshl_add_u32 v3, v6, 3, v3
    v_lshl_add_u32 v3, v3, 2, v11
    v_cvt_pk_bf16_f32 v14, v14, v15
    ds_write_b32 v3, v14 offset:0
    v_cvt_pk_bf16_f32 v44, v44, v45
    ds_write_b32 v3, v44 offset:256
    v_cvt_pk_bf16_f32 v24, v24, v25
    ds_write_b32 v3, v24 offset:512
    v_cvt_pk_bf16_f32 v48, v48, v49
    ds_write_b32 v3, v48 offset:768
    v_cvt_pk_bf16_f32 v22, v22, v23
    ds_write_b32 v3, v22 offset:1024
    v_cvt_pk_bf16_f32 v46, v46, v47
    ds_write_b32 v3, v46 offset:1280
    v_cvt_pk_bf16_f32 v26, v26, v27
    ds_write_b32 v3, v26 offset:1536
    v_cvt_pk_bf16_f32 v50, v50, v51
    ds_write_b32 v3, v50 offset:1792
    v_lshl_add_u32 v3, v1, 5, v11
    s_waitcnt lgkmcnt(0)
    ds_read_b128 v[52:55], v3
    ds_read_b128 v[56:59], v3 offset:16
    v_readfirstlane_b32 s36, v4
    v_readfirstlane_b32 s37, v5
    s_nop 0
    v_sub_f32 v6, 1.0, s36
    v_sub_f32 v7, 1.0, s37
    v_cvt_pk_bf16_f32 v8, v6, v7
    v_lshlrev_b32 v12, 16, v8
    v_and_b32 v13, 0xffff0000, v8
    s_waitcnt vmcnt(0) lgkmcnt(0)
    v_lshlrev_b32 v6, 16, v52
    v_and_b32 v7, 0xffff0000, v52
    v_mul_f32 v6, s36, v6
    v_mul_f32 v7, s37, v7
    v_cvt_pk_bf16_f32 v8, v6, v7
    v_lshlrev_b32 v6, 16, v8
    v_and_b32 v7, 0xffff0000, v8
    v_lshlrev_b32 v8, 16, v32
    v_lshlrev_b32 v9, 16, v36
    v_mul_f32 v8, v12, v8
    v_mul_f32 v9, v13, v9
    v_cvt_pk_bf16_f32 v8, v8, v9
    v_lshlrev_b32 v9, 16, v8
    v_and_b32 v8, 0xffff0000, v8
    v_add_f32 v20, v6, v9
    v_add_f32 v40, v7, v8
    v_lshlrev_b32 v6, 16, v53
    v_and_b32 v7, 0xffff0000, v53
    v_mul_f32 v6, s36, v6
    v_mul_f32 v7, s37, v7
    v_cvt_pk_bf16_f32 v8, v6, v7
    v_lshlrev_b32 v6, 16, v8
    v_and_b32 v7, 0xffff0000, v8
    v_and_b32 v8, 0xffff0000, v32
    v_and_b32 v9, 0xffff0000, v36
    v_mul_f32 v8, v12, v8
    v_mul_f32 v9, v13, v9
    v_cvt_pk_bf16_f32 v8, v8, v9
    v_lshlrev_b32 v9, 16, v8
    v_and_b32 v8, 0xffff0000, v8
    v_add_f32 v21, v6, v9
    v_add_f32 v41, v7, v8
    v_cvt_pk_bf16_f32 v16, v20, v21
    v_cvt_pk_bf16_f32 v28, v40, v41
    v_lshlrev_b32 v6, 16, v54
    v_and_b32 v7, 0xffff0000, v54
    v_mul_f32 v6, s36, v6
    v_mul_f32 v7, s37, v7
    v_cvt_pk_bf16_f32 v8, v6, v7
    v_lshlrev_b32 v6, 16, v8
    v_and_b32 v7, 0xffff0000, v8
    v_lshlrev_b32 v8, 16, v33
    v_lshlrev_b32 v9, 16, v37
    v_mul_f32 v8, v12, v8
    v_mul_f32 v9, v13, v9
    v_cvt_pk_bf16_f32 v8, v8, v9
    v_lshlrev_b32 v9, 16, v8
    v_and_b32 v8, 0xffff0000, v8
    v_add_f32 v20, v6, v9
    v_add_f32 v40, v7, v8
    v_lshlrev_b32 v6, 16, v55
    v_and_b32 v7, 0xffff0000, v55
    v_mul_f32 v6, s36, v6
    v_mul_f32 v7, s37, v7
    v_cvt_pk_bf16_f32 v8, v6, v7
    v_lshlrev_b32 v6, 16, v8
    v_and_b32 v7, 0xffff0000, v8
    v_and_b32 v8, 0xffff0000, v33
    v_and_b32 v9, 0xffff0000, v37
    v_mul_f32 v8, v12, v8
    v_mul_f32 v9, v13, v9
    v_cvt_pk_bf16_f32 v8, v8, v9
    v_lshlrev_b32 v9, 16, v8
    v_and_b32 v8, 0xffff0000, v8
    v_add_f32 v21, v6, v9
    v_add_f32 v41, v7, v8
    v_cvt_pk_bf16_f32 v17, v20, v21
    v_cvt_pk_bf16_f32 v29, v40, v41
    v_lshlrev_b32 v6, 16, v56
    v_and_b32 v7, 0xffff0000, v56
    v_mul_f32 v6, s36, v6
    v_mul_f32 v7, s37, v7
    v_cvt_pk_bf16_f32 v8, v6, v7
    v_lshlrev_b32 v6, 16, v8
    v_and_b32 v7, 0xffff0000, v8
    v_lshlrev_b32 v8, 16, v34
    v_lshlrev_b32 v9, 16, v38
    v_mul_f32 v8, v12, v8
    v_mul_f32 v9, v13, v9
    v_cvt_pk_bf16_f32 v8, v8, v9
    v_lshlrev_b32 v9, 16, v8
    v_and_b32 v8, 0xffff0000, v8
    v_add_f32 v20, v6, v9
    v_add_f32 v40, v7, v8
    v_lshlrev_b32 v6, 16, v57
    v_and_b32 v7, 0xffff0000, v57
    v_mul_f32 v6, s36, v6
    v_mul_f32 v7, s37, v7
    v_cvt_pk_bf16_f32 v8, v6, v7
    v_lshlrev_b32 v6, 16, v8
    v_and_b32 v7, 0xffff0000, v8
    v_and_b32 v8, 0xffff0000, v34
    v_and_b32 v9, 0xffff0000, v38
    v_mul_f32 v8, v12, v8
    v_mul_f32 v9, v13, v9
    v_cvt_pk_bf16_f32 v8, v8, v9
    v_lshlrev_b32 v9, 16, v8
    v_and_b32 v8, 0xffff0000, v8
    v_add_f32 v21, v6, v9
    v_add_f32 v41, v7, v8
    v_cvt_pk_bf16_f32 v18, v20, v21
    v_cvt_pk_bf16_f32 v30, v40, v41
    v_lshlrev_b32 v6, 16, v58
    v_and_b32 v7, 0xffff0000, v58
    v_mul_f32 v6, s36, v6
    v_mul_f32 v7, s37, v7
    v_cvt_pk_bf16_f32 v8, v6, v7
    v_lshlrev_b32 v6, 16, v8
    v_and_b32 v7, 0xffff0000, v8
    v_lshlrev_b32 v8, 16, v35
    v_lshlrev_b32 v9, 16, v39
    v_mul_f32 v8, v12, v8
    v_mul_f32 v9, v13, v9
    v_cvt_pk_bf16_f32 v8, v8, v9
    v_lshlrev_b32 v9, 16, v8
    v_and_b32 v8, 0xffff0000, v8
    v_add_f32 v20, v6, v9
    v_add_f32 v40, v7, v8
    v_lshlrev_b32 v6, 16, v59
    v_and_b32 v7, 0xffff0000, v59
    v_mul_f32 v6, s36, v6
    v_mul_f32 v7, s37, v7
    v_cvt_pk_bf16_f32 v8, v6, v7
    v_lshlrev_b32 v6, 16, v8
    v_and_b32 v7, 0xffff0000, v8
    v_and_b32 v8, 0xffff0000, v35
    v_and_b32 v9, 0xffff0000, v39
    v_mul_f32 v8, v12, v8
    v_mul_f32 v9, v13, v9
    v_cvt_pk_bf16_f32 v8, v8, v9
    v_lshlrev_b32 v9, 16, v8
    v_and_b32 v8, 0xffff0000, v8
    v_add_f32 v21, v6, v9
    v_add_f32 v41, v7, v8
    v_cvt_pk_bf16_f32 v19, v20, v21
    v_cvt_pk_bf16_f32 v31, v40, v41
    buffer_store_dwordx4 v[16:19], v10, s[16:19], s15 offen
    buffer_store_dwordx4 v[28:31], v10, s[16:19], s28 offen
    s_endpgm
K3_EXIT:
    s_endpgm
.section .rodata,"a"
.p2align 6

.amdhsa_kernel k1_kernel
  .amdhsa_next_free_vgpr 256
  .amdhsa_next_free_sgpr 100
  .amdhsa_accum_offset 256
  .amdhsa_group_segment_fixed_size 0
  .amdhsa_kernarg_size 88
  .amdhsa_user_sgpr_count 2
  .amdhsa_user_sgpr_kernarg_segment_ptr 1
  .amdhsa_system_sgpr_workgroup_id_x 1
.end_amdhsa_kernel
.p2align 6

.amdhsa_kernel k2_kernel
  .amdhsa_next_free_vgpr 256
  .amdhsa_next_free_sgpr 100
  .amdhsa_accum_offset 256
  .amdhsa_group_segment_fixed_size 0
  .amdhsa_kernarg_size 88
  .amdhsa_user_sgpr_count 2
  .amdhsa_user_sgpr_kernarg_segment_ptr 1
  .amdhsa_system_sgpr_workgroup_id_x 1
.end_amdhsa_kernel
.p2align 6

.amdhsa_kernel k3_kernel
  .amdhsa_next_free_vgpr 80
  .amdhsa_next_free_sgpr 100
  .amdhsa_accum_offset 80
  .amdhsa_group_segment_fixed_size 0
  .amdhsa_kernarg_size 88
  .amdhsa_user_sgpr_count 2
  .amdhsa_user_sgpr_kernarg_segment_ptr 1
  .amdhsa_system_sgpr_workgroup_id_x 1
.end_amdhsa_kernel
```
